```python
import torch

def _softmax(x, axis=-1):
    return torch.softmax(x, dim=axis)
def _gelu(x):
    return torch.nn.functional.gelu(x, approximate="tanh")
def _silu(x):
    return torch.nn.functional.silu(x)
def _sigmoid(x):
    return torch.sigmoid(x)
def _layernorm(x, axis=-1, eps=1e-5):
    m = x.mean(dim=axis, keepdim=True)
    v = x.var(dim=axis, keepdim=True, unbiased=False)
    return (x - m) / torch.sqrt(v + eps)
def _scatter_add(tgt, idx, src, axis=0):
    return tgt.clone().index_add_(axis, idx, src)
def _segment_sum(src, seg, n):
    out = torch.zeros((n,) + src.shape[1:], dtype=src.dtype)
    return out.index_add_(0, seg, src)
def _pad(x, pw):
    flat = tuple(v for pair in reversed(pw) for v in pair)
    return torch.nn.functional.pad(x, flat)

kernel_name = 'standalone__gqa_softmax__near_ridge'

def setup_inputs():

    _w = (lambda a: (lambda t: t.to(torch.bfloat16) if t.is_floating_point() else t)(torch.as_tensor(a)))
    B, Hq, Hkv, Sq, Sk, D = 8, 32, 32, 240, 1024, 128
    return {
        "q": _w((lambda *s: torch.randn(*s, dtype=torch.bfloat16) * 0.8)(B, Hq, Sq, D)),
        "k": _w((lambda *s: torch.randn(*s, dtype=torch.bfloat16) * 0.8)(B, Hkv, Sk, D)),
        "v": _w((lambda *s: torch.randn(*s, dtype=torch.bfloat16) * 0.05)(B, Hkv, Sk, D)),
    }

def reference(q, k, v):
    B, Hq, Sq, D = q.shape
    Hkv = k.shape[1]
    rep = Hq // Hkv
    k = (lambda x, n, axis: torch.repeat_interleave(x, n, dim=axis))(k, rep, axis=1)
    v = (lambda x, n, axis: torch.repeat_interleave(x, n, dim=axis))(v, rep, axis=1)
    scale = D ** -0.5
    scores = torch.einsum("bhqd,bhkd->bhqk", q, k) * scale
    p = _softmax(scores, axis=-1)
    return torch.einsum("bhqk,bhkd->bhqd", p, v)
```

```asm
; @launch grid=(256,1,1) block=(512,1,1) lds=163840
.amdgcn_target "amdgcn-amd-amdhsa--gfx950"
.text
.globl standalone__gqa_softmax__near_ridge_kernel
.p2align 8
.type standalone__gqa_softmax__near_ridge_kernel,@function
standalone__gqa_softmax__near_ridge_kernel:
    s_cmp_ge_u32 s2, 256
    s_cbranch_scc1 L_end
    s_load_dwordx8 s[4:11], s[0:1], 0
    v_lshrrev_b32 v1, 6, v0
    v_and_b32 v15, 63, v0
    s_nop 0
    v_readfirstlane_b32 s31, v1
    v_lshrrev_b32 v6, 4, v15
    v_lshl_add_u32 v7, v1, 3, v6
    v_and_b32 v8, 15, v15
    v_and_b32 v9, 15, v7
    v_xor_b32 v9, v8, v9
    v_lshlrev_b32 v9, 4, v9
    v_lshl_add_u32 v10, v7, 8, v9
    v_add_u32 v9, 4, v7
    v_and_b32 v9, 15, v9
    v_xor_b32 v9, v8, v9
    v_lshlrev_b32 v9, 4, v9
    v_lshl_add_u32 v11, v7, 8, v9
    v_lshlrev_b32 v9, 2, v6
    v_xor_b32 v9, v8, v9
    v_lshlrev_b32 v9, 4, v9
    v_lshl_add_u32 v12, v7, 8, v9
    v_lshrrev_b32 v6, 5, v15
    v_and_b32 v7, 31, v15
    v_xor_b32 v8, v8, v6
    v_xor_b32 v9, 0, v8
    v_lshlrev_b32 v9, 4, v9
    v_lshl_add_u32 v16, v7, 8, v9
    v_xor_b32 v9, 2, v8
    v_lshlrev_b32 v9, 4, v9
    v_lshl_add_u32 v17, v7, 8, v9
    v_xor_b32 v9, 4, v8
    v_lshlrev_b32 v9, 4, v9
    v_lshl_add_u32 v18, v7, 8, v9
    v_xor_b32 v9, 6, v8
    v_lshlrev_b32 v9, 4, v9
    v_lshl_add_u32 v19, v7, 8, v9
    v_xor_b32 v9, 8, v8
    v_lshlrev_b32 v9, 4, v9
    v_lshl_add_u32 v20, v7, 8, v9
    v_xor_b32 v9, 10, v8
    v_lshlrev_b32 v9, 4, v9
    v_lshl_add_u32 v21, v7, 8, v9
    v_xor_b32 v9, 12, v8
    v_lshlrev_b32 v9, 4, v9
    v_lshl_add_u32 v22, v7, 8, v9
    v_xor_b32 v9, 14, v8
    v_lshlrev_b32 v9, 4, v9
    v_lshl_add_u32 v23, v7, 8, v9
    v_bfe_u32 v9, v15, 2, 2
    v_lshl_add_u32 v8, v6, 2, v9
    v_lshlrev_b32 v8, 8, v8
    v_bfe_u32 v1, v15, 4, 1
    v_lshlrev_b32 v1, 5, v1
    v_add_u32 v8, v8, v1
    v_and_b32 v1, 3, v15
    v_lshlrev_b32 v1, 3, v1
    v_add_u32 v8, v8, v1
    v_add_u32 v8, 65536, v8
    v_xor_b32 v1, 0, v9
    v_lshl_add_u32 v24, v1, 6, v8
    v_xor_b32 v1, 1, v9
    v_lshl_add_u32 v25, v1, 6, v8
    v_xor_b32 v1, 2, v9
    v_lshl_add_u32 v26, v1, 6, v8
    v_xor_b32 v1, 3, v9
    v_lshl_add_u32 v27, v1, 6, v8
    v_lshrrev_b32 v1, 6, v0
    v_lshl_add_u32 v1, v1, 5, v7
    v_lshlrev_b32 v1, 8, v1
    v_lshl_add_u32 v13, v6, 4, v1
    s_waitcnt lgkmcnt(0)
    s_mul_i32 s36, s2, 61440
    s_lshl_b32 s37, s2, 18
    s_add_u32 s12, s4, s36
    s_addc_u32 s13, s5, 0
    s_mov_b32 s14, 61440
    s_mov_b32 s15, 0x00020000
    s_add_u32 s16, s6, s37
    s_addc_u32 s17, s7, 0
    s_mov_b32 s18, 262144
    s_mov_b32 s19, 0x00020000
    s_add_u32 s20, s8, s37
    s_addc_u32 s21, s9, 0
    s_mov_b32 s22, 262144
    s_mov_b32 s23, 0x00020000
    s_add_u32 s24, s10, s36
    s_addc_u32 s25, s11, 0
    s_mov_b32 s26, 61440
    s_mov_b32 s27, 0x00020000
    s_lshl_b32 s32, s31, 11
    s_add_u32 s33, s32, 65536
    s_mov_b32 s28, 0
    s_mov_b32 s29, 0
    s_mov_b32 s35, 0x41000000
    s_mov_b32 s34, 0x3e0293ee
    s_lshl_b32 s40, s31, 13
    s_add_u32 s41, s40, 131072
    s_add_u32 s42, s40, 81920
    s_add_u32 s43, s40, 0
    s_cmp_lt_u32 s31, 6
    s_cselect_b32 s43, s42, s43
    s_cmp_lt_u32 s31, 4
    s_cselect_b32 s41, s41, s43
    s_mov_b32 s42, 4096
    v_and_b32 v128, 63, v0
    v_lshrrev_b32 v129, 4, v128
    v_and_b32 v130, 15, v128
    v_lshrrev_b32 v131, 6, v0
    v_lshl_add_u32 v131, v131, 5, v129
    v_lshlrev_b32 v131, 8, v131
    v_add_u32 v132, 0, v129
    v_xor_b32 v132, v130, v132
    v_lshl_add_u32 v136, v132, 4, v131
    v_add_u32 v132, 4, v129
    v_xor_b32 v132, v130, v132
    v_lshl_add_u32 v137, v132, 4, v131
    v_add_u32 v132, 8, v129
    v_xor_b32 v132, v130, v132
    v_lshl_add_u32 v138, v132, 4, v131
    v_add_u32 v132, 12, v129
    v_xor_b32 v132, v130, v132
    v_lshl_add_u32 v139, v132, 4, v131
    s_add_u32 m0, s41, 0
    s_nop 0
    buffer_load_dwordx4 v136, s[12:15], 0 offen offset:0 nt lds
    buffer_load_dwordx4 v137, s[12:15], 0 offen offset:1024 nt lds
    buffer_load_dwordx4 v138, s[12:15], 0 offen offset:2048 nt lds
    buffer_load_dwordx4 v139, s[12:15], 0 offen offset:3072 nt lds
    s_add_u32 m0, s41, 4096
    s_nop 0
    buffer_load_dwordx4 v136, s[12:15], s42 offen offset:0 nt lds
    buffer_load_dwordx4 v137, s[12:15], s42 offen offset:1024 nt lds
    buffer_load_dwordx4 v138, s[12:15], s42 offen offset:2048 nt lds
    buffer_load_dwordx4 v139, s[12:15], s42 offen offset:3072 nt lds
    s_add_u32 m0, s32, 0
    s_nop 0
    buffer_load_dwordx4 v10, s[16:19], s28 offen nt lds
    buffer_load_dwordx4 v11, s[16:19], s28 offen offset:1024 nt lds
    s_add_u32 s28, s28, 16384
    s_add_u32 m0, s32, 16384
    s_nop 0
    buffer_load_dwordx4 v10, s[16:19], s28 offen nt lds
    buffer_load_dwordx4 v11, s[16:19], s28 offen offset:1024 nt lds
    s_add_u32 s28, s28, 16384
    s_add_u32 m0, s33, 0
    s_nop 0
    buffer_load_dwordx4 v12, s[20:23], s29 offen nt lds
    buffer_load_dwordx4 v12, s[20:23], s29 offen offset:1024 nt lds
    s_add_u32 s29, s29, 16384
    s_add_u32 m0, s32, 32768
    s_nop 0
    buffer_load_dwordx4 v10, s[16:19], s28 offen nt lds
    buffer_load_dwordx4 v11, s[16:19], s28 offen offset:1024 nt lds
    s_add_u32 s28, s28, 16384
    s_add_u32 m0, s33, 16384
    s_nop 0
    buffer_load_dwordx4 v12, s[20:23], s29 offen nt lds
    buffer_load_dwordx4 v12, s[20:23], s29 offen offset:1024 nt lds
    s_add_u32 s29, s29, 16384
    v_mov_b32 v2, 0xff800000
    v_mov_b32 v4, 0xff800000
    v_mov_b32 v3, 0
    v_mov_b32 v14, 0
    v_mov_b32 v15, 0
    v_mov_b32 v8, 0
    v_mov_b32 v9, 0
    s_mov_b32 s38, s34
    s_mov_b32 s39, s34
    v_mov_b32 v64, 0
    v_mov_b32 v65, 0
    v_mov_b32 v66, 0
    v_mov_b32 v67, 0
    v_mov_b32 v68, 0
    v_mov_b32 v69, 0
    v_mov_b32 v70, 0
    v_mov_b32 v71, 0
    v_mov_b32 v72, 0
    v_mov_b32 v73, 0
    v_mov_b32 v74, 0
    v_mov_b32 v75, 0
    v_mov_b32 v76, 0
    v_mov_b32 v77, 0
    v_mov_b32 v78, 0
    v_mov_b32 v79, 0
    v_mov_b32 v80, 0
    v_mov_b32 v81, 0
    v_mov_b32 v82, 0
    v_mov_b32 v83, 0
    v_mov_b32 v84, 0
    v_mov_b32 v85, 0
    v_mov_b32 v86, 0
    v_mov_b32 v87, 0
    v_mov_b32 v88, 0
    v_mov_b32 v89, 0
    v_mov_b32 v90, 0
    v_mov_b32 v91, 0
    v_mov_b32 v92, 0
    v_mov_b32 v93, 0
    v_mov_b32 v94, 0
    v_mov_b32 v95, 0
    v_mov_b32 v96, 0
    v_mov_b32 v97, 0
    v_mov_b32 v98, 0
    v_mov_b32 v99, 0
    v_mov_b32 v100, 0
    v_mov_b32 v101, 0
    v_mov_b32 v102, 0
    v_mov_b32 v103, 0
    v_mov_b32 v104, 0
    v_mov_b32 v105, 0
    v_mov_b32 v106, 0
    v_mov_b32 v107, 0
    v_mov_b32 v108, 0
    v_mov_b32 v109, 0
    v_mov_b32 v110, 0
    v_mov_b32 v111, 0
    v_mov_b32 v112, 0
    v_mov_b32 v113, 0
    v_mov_b32 v114, 0
    v_mov_b32 v115, 0
    v_mov_b32 v116, 0
    v_mov_b32 v117, 0
    v_mov_b32 v118, 0
    v_mov_b32 v119, 0
    v_mov_b32 v120, 0
    v_mov_b32 v121, 0
    v_mov_b32 v122, 0
    v_mov_b32 v123, 0
    v_mov_b32 v124, 0
    v_mov_b32 v125, 0
    v_mov_b32 v126, 0
    v_mov_b32 v127, 0
    v_add_u32 v144, s41, v16
    v_add_u32 v145, s41, v17
    v_add_u32 v146, s41, v18
    v_add_u32 v147, s41, v19
    v_add_u32 v148, s41, v20
    v_add_u32 v149, s41, v21
    v_add_u32 v150, s41, v22
    v_add_u32 v151, s41, v23
    s_waitcnt vmcnt(10)
    ds_read_b128 v[32:35], v144
    ds_read_b128 v[36:39], v145
    ds_read_b128 v[40:43], v146
    ds_read_b128 v[44:47], v147
    ds_read_b128 v[48:51], v148
    ds_read_b128 v[52:55], v149
    ds_read_b128 v[56:59], v150
    ds_read_b128 v[60:63], v151
    s_waitcnt vmcnt(6) lgkmcnt(0)
    s_barrier
    s_add_u32 m0, s32, 49152
    s_nop 0
    buffer_load_dwordx4 v10, s[16:19], s28 offen nt lds
    buffer_load_dwordx4 v11, s[16:19], s28 offen offset:1024 nt lds
    s_add_u32 s28, s28, 16384
    s_add_u32 m0, s33, 32768
    s_nop 0
    buffer_load_dwordx4 v12, s[20:23], s29 offen nt lds
    buffer_load_dwordx4 v12, s[20:23], s29 offen offset:1024 nt lds
    s_add_u32 s29, s29, 16384
    ds_read_b128 v[208:211], v16 offset:0
    ds_read_b128 v[212:215], v17 offset:0
    ds_read_b128 v[216:219], v18 offset:0
    ds_read_b128 v[220:223], v19 offset:0
    s_waitcnt lgkmcnt(3)
    v_mfma_f32_32x32x16_bf16 v[128:143], v[208:211], v[32:35], 0
    ds_read_b128 v[224:227], v20 offset:0
    s_waitcnt lgkmcnt(3)
    v_mfma_f32_32x32x16_bf16 v[128:143], v[212:215], v[36:39], v[128:143]
    ds_read_b128 v[228:231], v21 offset:0
    s_waitcnt lgkmcnt(3)
    v_mfma_f32_32x32x16_bf16 v[128:143], v[216:219], v[40:43], v[128:143]
    ds_read_b128 v[208:211], v22 offset:0
    s_waitcnt lgkmcnt(3)
    v_mfma_f32_32x32x16_bf16 v[128:143], v[220:223], v[44:47], v[128:143]
    ds_read_b128 v[212:215], v23 offset:0
    s_waitcnt lgkmcnt(3)
    v_mfma_f32_32x32x16_bf16 v[128:143], v[224:227], v[48:51], v[128:143]
    ds_read_b128 v[216:219], v16 offset:8192
    s_waitcnt lgkmcnt(3)
    v_mfma_f32_32x32x16_bf16 v[128:143], v[228:231], v[52:55], v[128:143]
    ds_read_b128 v[220:223], v17 offset:8192
    s_waitcnt lgkmcnt(3)
    v_mfma_f32_32x32x16_bf16 v[128:143], v[208:211], v[56:59], v[128:143]
    ds_read_b128 v[224:227], v18 offset:8192
    s_waitcnt lgkmcnt(3)
    v_mfma_f32_32x32x16_bf16 v[128:143], v[212:215], v[60:63], v[128:143]
    ds_read_b128 v[228:231], v19 offset:8192
    s_waitcnt lgkmcnt(3)
    v_mfma_f32_32x32x16_bf16 v[144:159], v[216:219], v[32:35], 0
    ds_read_b128 v[208:211], v20 offset:8192
    s_waitcnt lgkmcnt(3)
    v_mfma_f32_32x32x16_bf16 v[144:159], v[220:223], v[36:39], v[144:159]
    ds_read_b128 v[212:215], v21 offset:8192
    s_waitcnt lgkmcnt(3)
    v_mfma_f32_32x32x16_bf16 v[144:159], v[224:227], v[40:43], v[144:159]
    ds_read_b128 v[216:219], v22 offset:8192
    s_waitcnt lgkmcnt(3)
    v_mfma_f32_32x32x16_bf16 v[144:159], v[228:231], v[44:47], v[144:159]
    ds_read_b128 v[220:223], v23 offset:8192
    s_waitcnt lgkmcnt(3)
    v_mfma_f32_32x32x16_bf16 v[144:159], v[208:211], v[48:51], v[144:159]
    ds_read_b128 v[208:211], v16 offset:16384
    s_waitcnt lgkmcnt(3)
    v_mfma_f32_32x32x16_bf16 v[144:159], v[212:215], v[52:55], v[144:159]
    ds_read_b128 v[212:215], v17 offset:16384
    s_waitcnt lgkmcnt(3)
    v_mfma_f32_32x32x16_bf16 v[144:159], v[216:219], v[56:59], v[144:159]
    ds_read_b128 v[216:219], v18 offset:16384
    s_waitcnt lgkmcnt(3)
    v_mfma_f32_32x32x16_bf16 v[144:159], v[220:223], v[60:63], v[144:159]
    ds_read_b128 v[220:223], v19 offset:16384
    s_nop 7
    s_nop 7
    s_mov_b32 s30, 0
L_loop:
    s_waitcnt vmcnt(6)
    s_barrier
    s_waitcnt lgkmcnt(3)
    v_mfma_f32_32x32x16_bf16 v[160:175], v[208:211], v[32:35], 0
    s_add_u32 m0, s32, 0
    s_nop 0
    buffer_load_dwordx4 v10, s[16:19], s28 offen nt lds
    buffer_load_dwordx4 v11, s[16:19], s28 offen offset:1024 nt lds
    s_add_u32 s28, s28, 16384
    ds_read_b128 v[224:227], v20 offset:16384
    v_max3_f32 v1, v128, v129, v130
    v_max3_f32 v6, v144, v145, v146
    v_max3_f32 v1, v1, v131, v132
    v_max3_f32 v6, v6, v147, v148
    v_max3_f32 v1, v1, v133, v134
    s_waitcnt lgkmcnt(3)
    v_mfma_f32_32x32x16_bf16 v[160:175], v[212:215], v[36:39], v[160:175]
    s_add_u32 m0, s33, 49152
    s_nop 0
    buffer_load_dwordx4 v12, s[20:23], s29 offen nt lds
    buffer_load_dwordx4 v12, s[20:23], s29 offen offset:1024 nt lds
    s_add_u32 s29, s29, 16384
    ds_read_b128 v[228:231], v21 offset:16384
    v_max3_f32 v6, v6, v149, v150
    v_max3_f32 v1, v1, v135, v136
    v_max3_f32 v6, v6, v151, v152
    v_max3_f32 v1, v1, v137, v138
    v_max3_f32 v6, v6, v153, v154
    s_waitcnt lgkmcnt(3)
    v_mfma_f32_32x32x16_bf16 v[160:175], v[216:219], v[40:43], v[160:175]
    ds_read_b128 v[208:211], v22 offset:16384
    v_max3_f32 v1, v1, v139, v140
    v_max3_f32 v6, v6, v155, v156
    v_max3_f32 v1, v1, v141, v142
    v_max3_f32 v6, v6, v157, v158
    v_max3_f32 v1, v1, v143, v159
    s_waitcnt lgkmcnt(3)
    v_mfma_f32_32x32x16_bf16 v[160:175], v[220:223], v[44:47], v[160:175]
    ds_read_b128 v[212:215], v23 offset:16384
    v_max_f32 v1, v1, v6
    v_mov_b32 v6, v1
    s_nop 1
    v_permlane32_swap_b32 v1, v6
    v_max_f32 v1, v1, v6
    s_waitcnt lgkmcnt(3)
    v_mfma_f32_32x32x16_bf16 v[160:175], v[224:227], v[48:51], v[160:175]
    ds_read_b128 v[216:219], v16 offset:24576
    v_fma_f32 v6, v1, s34, -v4
    v_cmp_lt_f32 vcc, s35, v6
    s_nop 4
    s_cbranch_vccnz L_rare0
L_back0:
    s_waitcnt lgkmcnt(3)
    v_mfma_f32_32x32x16_bf16 v[160:175], v[228:231], v[52:55], v[160:175]
    ds_read_b128 v[220:223], v17 offset:24576
    v_fma_f32 v128, v128, s34, -v4
    v_fma_f32 v129, v129, s34, -v4
    v_fma_f32 v130, v130, s34, -v4
    v_fma_f32 v131, v131, s34, -v4
    v_exp_f32 v128, v128
    v_exp_f32 v129, v129
    v_exp_f32 v130, v130
    s_waitcnt lgkmcnt(3)
    v_mfma_f32_32x32x16_bf16 v[160:175], v[208:211], v[56:59], v[160:175]
    ds_read_b128 v[224:227], v18 offset:24576
    v_exp_f32 v131, v131
    v_fma_f32 v132, v132, s34, -v4
    v_fma_f32 v133, v133, s34, -v4
    v_fma_f32 v134, v134, s34, -v4
    v_fma_f32 v135, v135, s34, -v4
    v_exp_f32 v132, v132
    v_exp_f32 v133, v133
    s_waitcnt lgkmcnt(3)
    v_mfma_f32_32x32x16_bf16 v[160:175], v[212:215], v[60:63], v[160:175]
    ds_read_b128 v[228:231], v19 offset:24576
    v_exp_f32 v134, v134
    v_exp_f32 v135, v135
    v_add_f32 v3, v3, v128
    v_add_f32 v3, v3, v129
    v_add_f32 v3, v3, v130
    v_add_f32 v3, v3, v131
    v_cvt_pk_bf16_f32 v192, v128, v129
    s_waitcnt lgkmcnt(3)
    v_mfma_f32_32x32x16_bf16 v[176:191], v[216:219], v[32:35], 0
    ds_read_b128 v[208:211], v20 offset:24576
    v_cvt_pk_bf16_f32 v193, v130, v131
    v_fma_f32 v136, v136, s34, -v4
    v_fma_f32 v137, v137, s34, -v4
    v_fma_f32 v138, v138, s34, -v4
    v_fma_f32 v139, v139, s34, -v4
    v_exp_f32 v136, v136
    v_exp_f32 v137, v137
    s_waitcnt lgkmcnt(3)
    v_mfma_f32_32x32x16_bf16 v[176:191], v[220:223], v[36:39], v[176:191]
    ds_read_b128 v[212:215], v21 offset:24576
    v_exp_f32 v138, v138
    v_exp_f32 v139, v139
    v_add_f32 v3, v3, v132
    v_add_f32 v3, v3, v133
    v_add_f32 v3, v3, v134
    v_add_f32 v3, v3, v135
    v_cvt_pk_bf16_f32 v194, v132, v133
    s_waitcnt lgkmcnt(3)
    v_mfma_f32_32x32x16_bf16 v[176:191], v[224:227], v[40:43], v[176:191]
    ds_read_b128 v[216:219], v22 offset:24576
    v_cvt_pk_bf16_f32 v195, v134, v135
    v_fma_f32 v140, v140, s34, -v4
    v_fma_f32 v141, v141, s34, -v4
    v_fma_f32 v142, v142, s34, -v4
    v_fma_f32 v143, v143, s34, -v4
    v_exp_f32 v140, v140
    v_exp_f32 v141, v141
    s_waitcnt lgkmcnt(3)
    v_mfma_f32_32x32x16_bf16 v[176:191], v[228:231], v[44:47], v[176:191]
    ds_read_b128 v[220:223], v23 offset:24576
    v_exp_f32 v142, v142
    v_exp_f32 v143, v143
    v_add_f32 v3, v3, v136
    v_add_f32 v3, v3, v137
    v_add_f32 v3, v3, v138
    v_add_f32 v3, v3, v139
    v_cvt_pk_bf16_f32 v196, v136, v137
    s_waitcnt lgkmcnt(3)
    v_mfma_f32_32x32x16_bf16 v[176:191], v[208:211], v[48:51], v[176:191]
    ds_read_b64_tr_b16 v[232:233], v24 offset:0
    ds_read_b64_tr_b16 v[234:235], v24 offset:2048
    v_cvt_pk_bf16_f32 v197, v138, v139
    s_nop 0
    v_add_f32 v3, v3, v140
    v_add_f32 v3, v3, v141
    v_add_f32 v3, v3, v142
    v_add_f32 v3, v3, v143
    v_cvt_pk_bf16_f32 v198, v140, v141
    s_waitcnt lgkmcnt(4)
    v_mfma_f32_32x32x16_bf16 v[176:191], v[212:215], v[52:55], v[176:191]
    ds_read_b64_tr_b16 v[236:237], v25 offset:0
    ds_read_b64_tr_b16 v[238:239], v25 offset:2048
    v_cvt_pk_bf16_f32 v199, v142, v143
    s_waitcnt lgkmcnt(5)
    v_mfma_f32_32x32x16_bf16 v[176:191], v[216:219], v[56:59], v[176:191]
    ds_read_b64_tr_b16 v[240:241], v26 offset:0
    ds_read_b64_tr_b16 v[242:243], v26 offset:2048
    s_waitcnt lgkmcnt(6)
    v_mfma_f32_32x32x16_bf16 v[176:191], v[220:223], v[60:63], v[176:191]
    ds_read_b64_tr_b16 v[244:245], v27 offset:0
    ds_read_b64_tr_b16 v[246:247], v27 offset:2048
    s_waitcnt lgkmcnt(6)
    v_mfma_f32_32x32x16_bf16 v[64:79], v[232:235], v[192:195], v[64:79]
    ds_read_b64_tr_b16 v[248:249], v24 offset:4096
    ds_read_b64_tr_b16 v[250:251], v24 offset:6144
    v_fma_f32 v144, v144, s34, -v4
    v_fma_f32 v145, v145, s34, -v4
    v_fma_f32 v146, v146, s34, -v4
    v_fma_f32 v147, v147, s34, -v4
    v_exp_f32 v144, v144
    v_exp_f32 v145, v145
    v_exp_f32 v146, v146
    v_exp_f32 v147, v147
    v_fma_f32 v148, v148, s34, -v4
    s_waitcnt lgkmcnt(6)
    v_mfma_f32_32x32x16_bf16 v[80:95], v[236:239], v[192:195], v[80:95]
    ds_read_b64_tr_b16 v[252:253], v25 offset:4096
    ds_read_b64_tr_b16 v[254:255], v25 offset:6144
    v_fma_f32 v149, v149, s34, -v4
    v_fma_f32 v150, v150, s34, -v4
    v_fma_f32 v151, v151, s34, -v4
    v_exp_f32 v148, v148
    v_exp_f32 v149, v149
    v_exp_f32 v150, v150
    v_exp_f32 v151, v151
    v_add_f32 v3, v3, v144
    v_add_f32 v3, v3, v145
    s_waitcnt lgkmcnt(6)
    v_mfma_f32_32x32x16_bf16 v[96:111], v[240:243], v[192:195], v[96:111]
    ds_read_b64_tr_b16 v[232:233], v26 offset:4096
    ds_read_b64_tr_b16 v[234:235], v26 offset:6144
    v_add_f32 v3, v3, v146
    v_add_f32 v3, v3, v147
    v_cvt_pk_bf16_f32 v200, v144, v145
    v_cvt_pk_bf16_f32 v201, v146, v147
    v_fma_f32 v152, v152, s34, -v4
    v_fma_f32 v153, v153, s34, -v4
    v_fma_f32 v154, v154, s34, -v4
    v_fma_f32 v155, v155, s34, -v4
    v_exp_f32 v152, v152
    s_waitcnt lgkmcnt(6)
    v_mfma_f32_32x32x16_bf16 v[112:127], v[244:247], v[192:195], v[112:127]
    ds_read_b64_tr_b16 v[236:237], v27 offset:4096
    ds_read_b64_tr_b16 v[238:239], v27 offset:6144
    v_exp_f32 v153, v153
    v_exp_f32 v154, v154
    v_exp_f32 v155, v155
    v_add_f32 v3, v3, v148
    v_add_f32 v3, v3, v149
    v_add_f32 v3, v3, v150
    v_add_f32 v3, v3, v151
    v_cvt_pk_bf16_f32 v202, v148, v149
    v_cvt_pk_bf16_f32 v203, v150, v151
    s_waitcnt lgkmcnt(6)
    v_mfma_f32_32x32x16_bf16 v[64:79], v[248:251], v[196:199], v[64:79]
    ds_read_b64_tr_b16 v[240:241], v24 offset:8192
    ds_read_b64_tr_b16 v[242:243], v24 offset:10240
    v_fma_f32 v156, v156, s34, -v4
    v_fma_f32 v157, v157, s34, -v4
    v_fma_f32 v158, v158, s34, -v4
    v_fma_f32 v159, v159, s34, -v4
    v_exp_f32 v156, v156
    v_exp_f32 v157, v157
    v_exp_f32 v158, v158
    v_exp_f32 v159, v159
    v_add_f32 v3, v3, v152
    s_waitcnt lgkmcnt(6)
    v_mfma_f32_32x32x16_bf16 v[80:95], v[252:255], v[196:199], v[80:95]
    ds_read_b64_tr_b16 v[244:245], v25 offset:8192
    ds_read_b64_tr_b16 v[246:247], v25 offset:10240
    v_add_f32 v3, v3, v153
    v_add_f32 v3, v3, v154
    v_add_f32 v3, v3, v155
    v_cvt_pk_bf16_f32 v204, v152, v153
    v_cvt_pk_bf16_f32 v205, v154, v155
    s_nop 0
    v_add_f32 v3, v3, v156
    v_add_f32 v3, v3, v157
    v_add_f32 v3, v3, v158
    s_waitcnt lgkmcnt(6)
    v_mfma_f32_32x32x16_bf16 v[96:111], v[232:235], v[196:199], v[96:111]
    ds_read_b64_tr_b16 v[248:249], v26 offset:8192
    ds_read_b64_tr_b16 v[250:251], v26 offset:10240
    v_add_f32 v3, v3, v159
    v_cvt_pk_bf16_f32 v206, v156, v157
    v_cvt_pk_bf16_f32 v207, v158, v159
    s_waitcnt lgkmcnt(6)
    v_mfma_f32_32x32x16_bf16 v[112:127], v[236:239], v[196:199], v[112:127]
    ds_read_b64_tr_b16 v[252:253], v27 offset:8192
    ds_read_b64_tr_b16 v[254:255], v27 offset:10240
    s_nop 1
    s_waitcnt lgkmcnt(6)
    v_mfma_f32_32x32x16_bf16 v[64:79], v[240:243], v[200:203], v[64:79]
    ds_read_b64_tr_b16 v[232:233], v24 offset:12288
    ds_read_b64_tr_b16 v[234:235], v24 offset:14336
    s_waitcnt lgkmcnt(6)
    v_mfma_f32_32x32x16_bf16 v[80:95], v[244:247], v[200:203], v[80:95]
    ds_read_b64_tr_b16 v[236:237], v25 offset:12288
    ds_read_b64_tr_b16 v[238:239], v25 offset:14336
    s_waitcnt lgkmcnt(6)
    v_mfma_f32_32x32x16_bf16 v[96:111], v[248:251], v[200:203], v[96:111]
    ds_read_b64_tr_b16 v[240:241], v26 offset:12288
    ds_read_b64_tr_b16 v[242:243], v26 offset:14336
    s_waitcnt lgkmcnt(6)
    v_mfma_f32_32x32x16_bf16 v[112:127], v[252:255], v[200:203], v[112:127]
    ds_read_b64_tr_b16 v[244:245], v27 offset:12288
    ds_read_b64_tr_b16 v[246:247], v27 offset:14336
    s_waitcnt lgkmcnt(6)
    v_mfma_f32_32x32x16_bf16 v[64:79], v[232:235], v[204:207], v[64:79]
    ds_read_b128 v[208:211], v16 offset:32768
    s_waitcnt lgkmcnt(5)
    v_mfma_f32_32x32x16_bf16 v[80:95], v[236:239], v[204:207], v[80:95]
    ds_read_b128 v[212:215], v17 offset:32768
    s_waitcnt lgkmcnt(4)
    v_mfma_f32_32x32x16_bf16 v[96:111], v[240:243], v[204:207], v[96:111]
    ds_read_b128 v[216:219], v18 offset:32768
    s_waitcnt lgkmcnt(3)
    v_mfma_f32_32x32x16_bf16 v[112:127], v[244:247], v[204:207], v[112:127]
    ds_read_b128 v[220:223], v19 offset:32768
    s_waitcnt vmcnt(6)
    s_barrier
    s_waitcnt lgkmcnt(3)
    v_mfma_f32_32x32x16_bf16 v[128:143], v[208:211], v[32:35], 0
    s_add_u32 m0, s32, 16384
    s_nop 0
    buffer_load_dwordx4 v10, s[16:19], s28 offen nt lds
    buffer_load_dwordx4 v11, s[16:19], s28 offen offset:1024 nt lds
    s_add_u32 s28, s28, 16384
    ds_read_b128 v[224:227], v20 offset:32768
    v_max3_f32 v1, v160, v161, v162
    v_max3_f32 v6, v176, v177, v178
    v_max3_f32 v1, v1, v163, v164
    v_max3_f32 v6, v6, v179, v180
    v_max3_f32 v1, v1, v165, v166
    s_waitcnt lgkmcnt(3)
    v_mfma_f32_32x32x16_bf16 v[128:143], v[212:215], v[36:39], v[128:143]
    s_add_u32 m0, s33, 0
    s_nop 0
    buffer_load_dwordx4 v12, s[20:23], s29 offen nt lds
    buffer_load_dwordx4 v12, s[20:23], s29 offen offset:1024 nt lds
    s_add_u32 s29, s29, 16384
    ds_read_b128 v[228:231], v21 offset:32768
    v_max3_f32 v6, v6, v181, v182
    v_max3_f32 v1, v1, v167, v168
    v_max3_f32 v6, v6, v183, v184
    v_max3_f32 v1, v1, v169, v170
    v_max3_f32 v6, v6, v185, v186
    s_waitcnt lgkmcnt(3)
    v_mfma_f32_32x32x16_bf16 v[128:143], v[216:219], v[40:43], v[128:143]
    ds_read_b128 v[208:211], v22 offset:32768
    v_max3_f32 v1, v1, v171, v172
    v_max3_f32 v6, v6, v187, v188
    v_max3_f32 v1, v1, v173, v174
    v_max3_f32 v6, v6, v189, v190
    v_max3_f32 v1, v1, v175, v191
    s_waitcnt lgkmcnt(3)
    v_mfma_f32_32x32x16_bf16 v[128:143], v[220:223], v[44:47], v[128:143]
    ds_read_b128 v[212:215], v23 offset:32768
    v_max_f32 v1, v1, v6
    v_mov_b32 v6, v1
    s_nop 1
    v_permlane32_swap_b32 v1, v6
    v_max_f32 v1, v1, v6
    s_waitcnt lgkmcnt(3)
    v_mfma_f32_32x32x16_bf16 v[128:143], v[224:227], v[48:51], v[128:143]
    ds_read_b128 v[216:219], v16 offset:40960
    v_fma_f32 v6, v1, s34, -v4
    v_cmp_lt_f32 vcc, s35, v6
    s_nop 4
    s_cbranch_vccnz L_rare1
L_back1:
    s_waitcnt lgkmcnt(3)
    v_mfma_f32_32x32x16_bf16 v[128:143], v[228:231], v[52:55], v[128:143]
    ds_read_b128 v[220:223], v17 offset:40960
    v_fma_f32 v160, v160, s34, -v4
    v_fma_f32 v161, v161, s34, -v4
    v_fma_f32 v162, v162, s34, -v4
    v_fma_f32 v163, v163, s34, -v4
    v_exp_f32 v160, v160
    v_exp_f32 v161, v161
    v_exp_f32 v162, v162
    s_waitcnt lgkmcnt(3)
    v_mfma_f32_32x32x16_bf16 v[128:143], v[208:211], v[56:59], v[128:143]
    ds_read_b128 v[224:227], v18 offset:40960
    v_exp_f32 v163, v163
    v_fma_f32 v164, v164, s34, -v4
    v_fma_f32 v165, v165, s34, -v4
    v_fma_f32 v166, v166, s34, -v4
    v_fma_f32 v167, v167, s34, -v4
    v_exp_f32 v164, v164
    v_exp_f32 v165, v165
    s_waitcnt lgkmcnt(3)
    v_mfma_f32_32x32x16_bf16 v[128:143], v[212:215], v[60:63], v[128:143]
    ds_read_b128 v[228:231], v19 offset:40960
    v_exp_f32 v166, v166
    v_exp_f32 v167, v167
    v_add_f32 v3, v3, v160
    v_add_f32 v3, v3, v161
    v_add_f32 v3, v3, v162
    v_add_f32 v3, v3, v163
    v_cvt_pk_bf16_f32 v192, v160, v161
    s_waitcnt lgkmcnt(3)
    v_mfma_f32_32x32x16_bf16 v[144:159], v[216:219], v[32:35], 0
    ds_read_b128 v[208:211], v20 offset:40960
    v_cvt_pk_bf16_f32 v193, v162, v163
    v_fma_f32 v168, v168, s34, -v4
    v_fma_f32 v169, v169, s34, -v4
    v_fma_f32 v170, v170, s34, -v4
    v_fma_f32 v171, v171, s34, -v4
    v_exp_f32 v168, v168
    v_exp_f32 v169, v169
    s_waitcnt lgkmcnt(3)
    v_mfma_f32_32x32x16_bf16 v[144:159], v[220:223], v[36:39], v[144:159]
    ds_read_b128 v[212:215], v21 offset:40960
    v_exp_f32 v170, v170
    v_exp_f32 v171, v171
    v_add_f32 v3, v3, v164
    v_add_f32 v3, v3, v165
    v_add_f32 v3, v3, v166
    v_add_f32 v3, v3, v167
    v_cvt_pk_bf16_f32 v194, v164, v165
    s_waitcnt lgkmcnt(3)
    v_mfma_f32_32x32x16_bf16 v[144:159], v[224:227], v[40:43], v[144:159]
    ds_read_b128 v[216:219], v22 offset:40960
    v_cvt_pk_bf16_f32 v195, v166, v167
    v_fma_f32 v172, v172, s34, -v4
    v_fma_f32 v173, v173, s34, -v4
    v_fma_f32 v174, v174, s34, -v4
    v_fma_f32 v175, v175, s34, -v4
    v_exp_f32 v172, v172
    v_exp_f32 v173, v173
    s_waitcnt lgkmcnt(3)
    v_mfma_f32_32x32x16_bf16 v[144:159], v[228:231], v[44:47], v[144:159]
    ds_read_b128 v[220:223], v23 offset:40960
    v_exp_f32 v174, v174
    v_exp_f32 v175, v175
    v_add_f32 v3, v3, v168
    v_add_f32 v3, v3, v169
    v_add_f32 v3, v3, v170
    v_add_f32 v3, v3, v171
    v_cvt_pk_bf16_f32 v196, v168, v169
    s_waitcnt lgkmcnt(3)
    v_mfma_f32_32x32x16_bf16 v[144:159], v[208:211], v[48:51], v[144:159]
    ds_read_b64_tr_b16 v[232:233], v24 offset:16384
    ds_read_b64_tr_b16 v[234:235], v24 offset:18432
    v_cvt_pk_bf16_f32 v197, v170, v171
    s_nop 0
    v_add_f32 v3, v3, v172
    v_add_f32 v3, v3, v173
    v_add_f32 v3, v3, v174
    v_add_f32 v3, v3, v175
    v_cvt_pk_bf16_f32 v198, v172, v173
    s_waitcnt lgkmcnt(4)
    v_mfma_f32_32x32x16_bf16 v[144:159], v[212:215], v[52:55], v[144:159]
    ds_read_b64_tr_b16 v[236:237], v25 offset:16384
    ds_read_b64_tr_b16 v[238:239], v25 offset:18432
    v_cvt_pk_bf16_f32 v199, v174, v175
    s_waitcnt lgkmcnt(5)
    v_mfma_f32_32x32x16_bf16 v[144:159], v[216:219], v[56:59], v[144:159]
    ds_read_b64_tr_b16 v[240:241], v26 offset:16384
    ds_read_b64_tr_b16 v[242:243], v26 offset:18432
    s_waitcnt lgkmcnt(6)
    v_mfma_f32_32x32x16_bf16 v[144:159], v[220:223], v[60:63], v[144:159]
    ds_read_b64_tr_b16 v[244:245], v27 offset:16384
    ds_read_b64_tr_b16 v[246:247], v27 offset:18432
    s_waitcnt lgkmcnt(6)
    v_mfma_f32_32x32x16_bf16 v[64:79], v[232:235], v[192:195], v[64:79]
    ds_read_b64_tr_b16 v[248:249], v24 offset:20480
    ds_read_b64_tr_b16 v[250:251], v24 offset:22528
    v_fma_f32 v176, v176, s34, -v4
    v_fma_f32 v177, v177, s34, -v4
    v_fma_f32 v178, v178, s34, -v4
    v_fma_f32 v179, v179, s34, -v4
    v_exp_f32 v176, v176
    v_exp_f32 v177, v177
    v_exp_f32 v178, v178
    v_exp_f32 v179, v179
    v_fma_f32 v180, v180, s34, -v4
    s_waitcnt lgkmcnt(6)
    v_mfma_f32_32x32x16_bf16 v[80:95], v[236:239], v[192:195], v[80:95]
    ds_read_b64_tr_b16 v[252:253], v25 offset:20480
    ds_read_b64_tr_b16 v[254:255], v25 offset:22528
    v_fma_f32 v181, v181, s34, -v4
    v_fma_f32 v182, v182, s34, -v4
    v_fma_f32 v183, v183, s34, -v4
    v_exp_f32 v180, v180
    v_exp_f32 v181, v181
    v_exp_f32 v182, v182
    v_exp_f32 v183, v183
    v_add_f32 v3, v3, v176
    v_add_f32 v3, v3, v177
    s_waitcnt lgkmcnt(6)
    v_mfma_f32_32x32x16_bf16 v[96:111], v[240:243], v[192:195], v[96:111]
    ds_read_b64_tr_b16 v[232:233], v26 offset:20480
    ds_read_b64_tr_b16 v[234:235], v26 offset:22528
    v_add_f32 v3, v3, v178
    v_add_f32 v3, v3, v179
    v_cvt_pk_bf16_f32 v200, v176, v177
    v_cvt_pk_bf16_f32 v201, v178, v179
    v_fma_f32 v184, v184, s34, -v4
    v_fma_f32 v185, v185, s34, -v4
    v_fma_f32 v186, v186, s34, -v4
    v_fma_f32 v187, v187, s34, -v4
    v_exp_f32 v184, v184
    s_waitcnt lgkmcnt(6)
    v_mfma_f32_32x32x16_bf16 v[112:127], v[244:247], v[192:195], v[112:127]
    ds_read_b64_tr_b16 v[236:237], v27 offset:20480
    ds_read_b64_tr_b16 v[238:239], v27 offset:22528
    v_exp_f32 v185, v185
    v_exp_f32 v186, v186
    v_exp_f32 v187, v187
    v_add_f32 v3, v3, v180
    v_add_f32 v3, v3, v181
    v_add_f32 v3, v3, v182
    v_add_f32 v3, v3, v183
    v_cvt_pk_bf16_f32 v202, v180, v181
    v_cvt_pk_bf16_f32 v203, v182, v183
    s_waitcnt lgkmcnt(6)
    v_mfma_f32_32x32x16_bf16 v[64:79], v[248:251], v[196:199], v[64:79]
    ds_read_b64_tr_b16 v[240:241], v24 offset:24576
    ds_read_b64_tr_b16 v[242:243], v24 offset:26624
    v_fma_f32 v188, v188, s34, -v4
    v_fma_f32 v189, v189, s34, -v4
    v_fma_f32 v190, v190, s34, -v4
    v_fma_f32 v191, v191, s34, -v4
    v_exp_f32 v188, v188
    v_exp_f32 v189, v189
    v_exp_f32 v190, v190
    v_exp_f32 v191, v191
    v_add_f32 v3, v3, v184
    s_waitcnt lgkmcnt(6)
    v_mfma_f32_32x32x16_bf16 v[80:95], v[252:255], v[196:199], v[80:95]
    ds_read_b64_tr_b16 v[244:245], v25 offset:24576
    ds_read_b64_tr_b16 v[246:247], v25 offset:26624
    v_add_f32 v3, v3, v185
    v_add_f32 v3, v3, v186
    v_add_f32 v3, v3, v187
    v_cvt_pk_bf16_f32 v204, v184, v185
    v_cvt_pk_bf16_f32 v205, v186, v187
    s_nop 0
    v_add_f32 v3, v3, v188
    v_add_f32 v3, v3, v189
    v_add_f32 v3, v3, v190
    s_waitcnt lgkmcnt(6)
    v_mfma_f32_32x32x16_bf16 v[96:111], v[232:235], v[196:199], v[96:111]
    ds_read_b64_tr_b16 v[248:249], v26 offset:24576
    ds_read_b64_tr_b16 v[250:251], v26 offset:26624
    v_add_f32 v3, v3, v191
    v_cvt_pk_bf16_f32 v206, v188, v189
    v_cvt_pk_bf16_f32 v207, v190, v191
    s_waitcnt lgkmcnt(6)
    v_mfma_f32_32x32x16_bf16 v[112:127], v[236:239], v[196:199], v[112:127]
    ds_read_b64_tr_b16 v[252:253], v27 offset:24576
    ds_read_b64_tr_b16 v[254:255], v27 offset:26624
    s_nop 1
    s_waitcnt lgkmcnt(6)
    v_mfma_f32_32x32x16_bf16 v[64:79], v[240:243], v[200:203], v[64:79]
    ds_read_b64_tr_b16 v[232:233], v24 offset:28672
    ds_read_b64_tr_b16 v[234:235], v24 offset:30720
    s_waitcnt lgkmcnt(6)
    v_mfma_f32_32x32x16_bf16 v[80:95], v[244:247], v[200:203], v[80:95]
    ds_read_b64_tr_b16 v[236:237], v25 offset:28672
    ds_read_b64_tr_b16 v[238:239], v25 offset:30720
    s_waitcnt lgkmcnt(6)
    v_mfma_f32_32x32x16_bf16 v[96:111], v[248:251], v[200:203], v[96:111]
    ds_read_b64_tr_b16 v[240:241], v26 offset:28672
    ds_read_b64_tr_b16 v[242:243], v26 offset:30720
    s_waitcnt lgkmcnt(6)
    v_mfma_f32_32x32x16_bf16 v[112:127], v[252:255], v[200:203], v[112:127]
    ds_read_b64_tr_b16 v[244:245], v27 offset:28672
    ds_read_b64_tr_b16 v[246:247], v27 offset:30720
    s_waitcnt lgkmcnt(6)
    v_mfma_f32_32x32x16_bf16 v[64:79], v[232:235], v[204:207], v[64:79]
    ds_read_b128 v[208:211], v16 offset:49152
    s_waitcnt lgkmcnt(5)
    v_mfma_f32_32x32x16_bf16 v[80:95], v[236:239], v[204:207], v[80:95]
    ds_read_b128 v[212:215], v17 offset:49152
    s_waitcnt lgkmcnt(4)
    v_mfma_f32_32x32x16_bf16 v[96:111], v[240:243], v[204:207], v[96:111]
    ds_read_b128 v[216:219], v18 offset:49152
    s_waitcnt lgkmcnt(3)
    v_mfma_f32_32x32x16_bf16 v[112:127], v[244:247], v[204:207], v[112:127]
    ds_read_b128 v[220:223], v19 offset:49152
    s_waitcnt vmcnt(6)
    s_barrier
    s_waitcnt lgkmcnt(3)
    v_mfma_f32_32x32x16_bf16 v[160:175], v[208:211], v[32:35], 0
    s_add_u32 m0, s32, 32768
    s_nop 0
    buffer_load_dwordx4 v10, s[16:19], s28 offen nt lds
    buffer_load_dwordx4 v11, s[16:19], s28 offen offset:1024 nt lds
    s_add_u32 s28, s28, 16384
    ds_read_b128 v[224:227], v20 offset:49152
    v_max3_f32 v1, v128, v129, v130
    v_max3_f32 v6, v144, v145, v146
    v_max3_f32 v1, v1, v131, v132
    v_max3_f32 v6, v6, v147, v148
    v_max3_f32 v1, v1, v133, v134
    s_waitcnt lgkmcnt(3)
    v_mfma_f32_32x32x16_bf16 v[160:175], v[212:215], v[36:39], v[160:175]
    s_add_u32 m0, s33, 16384
    s_nop 0
    buffer_load_dwordx4 v12, s[20:23], s29 offen nt lds
    buffer_load_dwordx4 v12, s[20:23], s29 offen offset:1024 nt lds
    s_add_u32 s29, s29, 16384
    ds_read_b128 v[228:231], v21 offset:49152
    v_max3_f32 v6, v6, v149, v150
    v_max3_f32 v1, v1, v135, v136
    v_max3_f32 v6, v6, v151, v152
    v_max3_f32 v1, v1, v137, v138
    v_max3_f32 v6, v6, v153, v154
    s_waitcnt lgkmcnt(3)
    v_mfma_f32_32x32x16_bf16 v[160:175], v[216:219], v[40:43], v[160:175]
    ds_read_b128 v[208:211], v22 offset:49152
    v_max3_f32 v1, v1, v139, v140
    v_max3_f32 v6, v6, v155, v156
    v_max3_f32 v1, v1, v141, v142
    v_max3_f32 v6, v6, v157, v158
    v_max3_f32 v1, v1, v143, v159
    s_waitcnt lgkmcnt(3)
    v_mfma_f32_32x32x16_bf16 v[160:175], v[220:223], v[44:47], v[160:175]
    ds_read_b128 v[212:215], v23 offset:49152
    v_max_f32 v1, v1, v6
    v_mov_b32 v6, v1
    s_nop 1
    v_permlane32_swap_b32 v1, v6
    v_max_f32 v1, v1, v6
    s_waitcnt lgkmcnt(3)
    v_mfma_f32_32x32x16_bf16 v[160:175], v[224:227], v[48:51], v[160:175]
    ds_read_b128 v[216:219], v16 offset:57344
    v_fma_f32 v6, v1, s34, -v4
    v_cmp_lt_f32 vcc, s35, v6
    s_nop 4
    s_cbranch_vccnz L_rare2
L_back2:
    s_waitcnt lgkmcnt(3)
    v_mfma_f32_32x32x16_bf16 v[160:175], v[228:231], v[52:55], v[160:175]
    ds_read_b128 v[220:223], v17 offset:57344
    v_fma_f32 v128, v128, s34, -v4
    v_fma_f32 v129, v129, s34, -v4
    v_fma_f32 v130, v130, s34, -v4
    v_fma_f32 v131, v131, s34, -v4
    v_exp_f32 v128, v128
    v_exp_f32 v129, v129
    v_exp_f32 v130, v130
    s_waitcnt lgkmcnt(3)
    v_mfma_f32_32x32x16_bf16 v[160:175], v[208:211], v[56:59], v[160:175]
    ds_read_b128 v[224:227], v18 offset:57344
    v_exp_f32 v131, v131
    v_fma_f32 v132, v132, s34, -v4
    v_fma_f32 v133, v133, s34, -v4
    v_fma_f32 v134, v134, s34, -v4
    v_fma_f32 v135, v135, s34, -v4
    v_exp_f32 v132, v132
    v_exp_f32 v133, v133
    s_waitcnt lgkmcnt(3)
    v_mfma_f32_32x32x16_bf16 v[160:175], v[212:215], v[60:63], v[160:175]
    ds_read_b128 v[228:231], v19 offset:57344
    v_exp_f32 v134, v134
    v_exp_f32 v135, v135
    v_add_f32 v3, v3, v128
    v_add_f32 v3, v3, v129
    v_add_f32 v3, v3, v130
    v_add_f32 v3, v3, v131
    v_cvt_pk_bf16_f32 v192, v128, v129
    s_waitcnt lgkmcnt(3)
    v_mfma_f32_32x32x16_bf16 v[176:191], v[216:219], v[32:35], 0
    ds_read_b128 v[208:211], v20 offset:57344
    v_cvt_pk_bf16_f32 v193, v130, v131
    v_fma_f32 v136, v136, s34, -v4
    v_fma_f32 v137, v137, s34, -v4
    v_fma_f32 v138, v138, s34, -v4
    v_fma_f32 v139, v139, s34, -v4
    v_exp_f32 v136, v136
    v_exp_f32 v137, v137
    s_waitcnt lgkmcnt(3)
    v_mfma_f32_32x32x16_bf16 v[176:191], v[220:223], v[36:39], v[176:191]
    ds_read_b128 v[212:215], v21 offset:57344
    v_exp_f32 v138, v138
    v_exp_f32 v139, v139
    v_add_f32 v3, v3, v132
    v_add_f32 v3, v3, v133
    v_add_f32 v3, v3, v134
    v_add_f32 v3, v3, v135
    v_cvt_pk_bf16_f32 v194, v132, v133
    s_waitcnt lgkmcnt(3)
    v_mfma_f32_32x32x16_bf16 v[176:191], v[224:227], v[40:43], v[176:191]
    ds_read_b128 v[216:219], v22 offset:57344
    v_cvt_pk_bf16_f32 v195, v134, v135
    v_fma_f32 v140, v140, s34, -v4
    v_fma_f32 v141, v141, s34, -v4
    v_fma_f32 v142, v142, s34, -v4
    v_fma_f32 v143, v143, s34, -v4
    v_exp_f32 v140, v140
    v_exp_f32 v141, v141
    s_waitcnt lgkmcnt(3)
    v_mfma_f32_32x32x16_bf16 v[176:191], v[228:231], v[44:47], v[176:191]
    ds_read_b128 v[220:223], v23 offset:57344
    v_exp_f32 v142, v142
    v_exp_f32 v143, v143
    v_add_f32 v3, v3, v136
    v_add_f32 v3, v3, v137
    v_add_f32 v3, v3, v138
    v_add_f32 v3, v3, v139
    v_cvt_pk_bf16_f32 v196, v136, v137
    s_waitcnt lgkmcnt(3)
    v_mfma_f32_32x32x16_bf16 v[176:191], v[208:211], v[48:51], v[176:191]
    ds_read_b64_tr_b16 v[232:233], v24 offset:32768
    ds_read_b64_tr_b16 v[234:235], v24 offset:34816
    v_cvt_pk_bf16_f32 v197, v138, v139
    s_nop 0
    v_add_f32 v3, v3, v140
    v_add_f32 v3, v3, v141
    v_add_f32 v3, v3, v142
    v_add_f32 v3, v3, v143
    v_cvt_pk_bf16_f32 v198, v140, v141
    s_waitcnt lgkmcnt(4)
    v_mfma_f32_32x32x16_bf16 v[176:191], v[212:215], v[52:55], v[176:191]
    ds_read_b64_tr_b16 v[236:237], v25 offset:32768
    ds_read_b64_tr_b16 v[238:239], v25 offset:34816
    v_cvt_pk_bf16_f32 v199, v142, v143
    s_waitcnt lgkmcnt(5)
    v_mfma_f32_32x32x16_bf16 v[176:191], v[216:219], v[56:59], v[176:191]
    ds_read_b64_tr_b16 v[240:241], v26 offset:32768
    ds_read_b64_tr_b16 v[242:243], v26 offset:34816
    s_waitcnt lgkmcnt(6)
    v_mfma_f32_32x32x16_bf16 v[176:191], v[220:223], v[60:63], v[176:191]
    ds_read_b64_tr_b16 v[244:245], v27 offset:32768
    ds_read_b64_tr_b16 v[246:247], v27 offset:34816
    s_waitcnt lgkmcnt(6)
    v_mfma_f32_32x32x16_bf16 v[64:79], v[232:235], v[192:195], v[64:79]
    ds_read_b64_tr_b16 v[248:249], v24 offset:36864
    ds_read_b64_tr_b16 v[250:251], v24 offset:38912
    v_fma_f32 v144, v144, s34, -v4
    v_fma_f32 v145, v145, s34, -v4
    v_fma_f32 v146, v146, s34, -v4
    v_fma_f32 v147, v147, s34, -v4
    v_exp_f32 v144, v144
    v_exp_f32 v145, v145
    v_exp_f32 v146, v146
    v_exp_f32 v147, v147
    v_fma_f32 v148, v148, s34, -v4
    s_waitcnt lgkmcnt(6)
    v_mfma_f32_32x32x16_bf16 v[80:95], v[236:239], v[192:195], v[80:95]
    ds_read_b64_tr_b16 v[252:253], v25 offset:36864
    ds_read_b64_tr_b16 v[254:255], v25 offset:38912
    v_fma_f32 v149, v149, s34, -v4
    v_fma_f32 v150, v150, s34, -v4
    v_fma_f32 v151, v151, s34, -v4
    v_exp_f32 v148, v148
    v_exp_f32 v149, v149
    v_exp_f32 v150, v150
    v_exp_f32 v151, v151
    v_add_f32 v3, v3, v144
    v_add_f32 v3, v3, v145
    s_waitcnt lgkmcnt(6)
    v_mfma_f32_32x32x16_bf16 v[96:111], v[240:243], v[192:195], v[96:111]
    ds_read_b64_tr_b16 v[232:233], v26 offset:36864
    ds_read_b64_tr_b16 v[234:235], v26 offset:38912
    v_add_f32 v3, v3, v146
    v_add_f32 v3, v3, v147
    v_cvt_pk_bf16_f32 v200, v144, v145
    v_cvt_pk_bf16_f32 v201, v146, v147
    v_fma_f32 v152, v152, s34, -v4
    v_fma_f32 v153, v153, s34, -v4
    v_fma_f32 v154, v154, s34, -v4
    v_fma_f32 v155, v155, s34, -v4
    v_exp_f32 v152, v152
    s_waitcnt lgkmcnt(6)
    v_mfma_f32_32x32x16_bf16 v[112:127], v[244:247], v[192:195], v[112:127]
    ds_read_b64_tr_b16 v[236:237], v27 offset:36864
    ds_read_b64_tr_b16 v[238:239], v27 offset:38912
    v_exp_f32 v153, v153
    v_exp_f32 v154, v154
    v_exp_f32 v155, v155
    v_add_f32 v3, v3, v148
    v_add_f32 v3, v3, v149
    v_add_f32 v3, v3, v150
    v_add_f32 v3, v3, v151
    v_cvt_pk_bf16_f32 v202, v148, v149
    v_cvt_pk_bf16_f32 v203, v150, v151
    s_waitcnt lgkmcnt(6)
    v_mfma_f32_32x32x16_bf16 v[64:79], v[248:251], v[196:199], v[64:79]
    ds_read_b64_tr_b16 v[240:241], v24 offset:40960
    ds_read_b64_tr_b16 v[242:243], v24 offset:43008
    v_fma_f32 v156, v156, s34, -v4
    v_fma_f32 v157, v157, s34, -v4
    v_fma_f32 v158, v158, s34, -v4
    v_fma_f32 v159, v159, s34, -v4
    v_exp_f32 v156, v156
    v_exp_f32 v157, v157
    v_exp_f32 v158, v158
    v_exp_f32 v159, v159
    v_add_f32 v3, v3, v152
    s_waitcnt lgkmcnt(6)
    v_mfma_f32_32x32x16_bf16 v[80:95], v[252:255], v[196:199], v[80:95]
    ds_read_b64_tr_b16 v[244:245], v25 offset:40960
    ds_read_b64_tr_b16 v[246:247], v25 offset:43008
    v_add_f32 v3, v3, v153
    v_add_f32 v3, v3, v154
    v_add_f32 v3, v3, v155
    v_cvt_pk_bf16_f32 v204, v152, v153
    v_cvt_pk_bf16_f32 v205, v154, v155
    s_nop 0
    v_add_f32 v3, v3, v156
    v_add_f32 v3, v3, v157
    v_add_f32 v3, v3, v158
    s_waitcnt lgkmcnt(6)
    v_mfma_f32_32x32x16_bf16 v[96:111], v[232:235], v[196:199], v[96:111]
    ds_read_b64_tr_b16 v[248:249], v26 offset:40960
    ds_read_b64_tr_b16 v[250:251], v26 offset:43008
    v_add_f32 v3, v3, v159
    v_cvt_pk_bf16_f32 v206, v156, v157
    v_cvt_pk_bf16_f32 v207, v158, v159
    s_waitcnt lgkmcnt(6)
    v_mfma_f32_32x32x16_bf16 v[112:127], v[236:239], v[196:199], v[112:127]
    ds_read_b64_tr_b16 v[252:253], v27 offset:40960
    ds_read_b64_tr_b16 v[254:255], v27 offset:43008
    s_nop 1
    s_waitcnt lgkmcnt(6)
    v_mfma_f32_32x32x16_bf16 v[64:79], v[240:243], v[200:203], v[64:79]
    ds_read_b64_tr_b16 v[232:233], v24 offset:45056
    ds_read_b64_tr_b16 v[234:235], v24 offset:47104
    s_waitcnt lgkmcnt(6)
    v_mfma_f32_32x32x16_bf16 v[80:95], v[244:247], v[200:203], v[80:95]
    ds_read_b64_tr_b16 v[236:237], v25 offset:45056
    ds_read_b64_tr_b16 v[238:239], v25 offset:47104
    s_waitcnt lgkmcnt(6)
    v_mfma_f32_32x32x16_bf16 v[96:111], v[248:251], v[200:203], v[96:111]
    ds_read_b64_tr_b16 v[240:241], v26 offset:45056
    ds_read_b64_tr_b16 v[242:243], v26 offset:47104
    s_waitcnt lgkmcnt(6)
    v_mfma_f32_32x32x16_bf16 v[112:127], v[252:255], v[200:203], v[112:127]
    ds_read_b64_tr_b16 v[244:245], v27 offset:45056
    ds_read_b64_tr_b16 v[246:247], v27 offset:47104
    s_waitcnt lgkmcnt(6)
    v_mfma_f32_32x32x16_bf16 v[64:79], v[232:235], v[204:207], v[64:79]
    ds_read_b128 v[208:211], v16 offset:0
    s_waitcnt lgkmcnt(5)
    v_mfma_f32_32x32x16_bf16 v[80:95], v[236:239], v[204:207], v[80:95]
    ds_read_b128 v[212:215], v17 offset:0
    s_waitcnt lgkmcnt(4)
    v_mfma_f32_32x32x16_bf16 v[96:111], v[240:243], v[204:207], v[96:111]
    ds_read_b128 v[216:219], v18 offset:0
    s_waitcnt lgkmcnt(3)
    v_mfma_f32_32x32x16_bf16 v[112:127], v[244:247], v[204:207], v[112:127]
    ds_read_b128 v[220:223], v19 offset:0
    s_waitcnt vmcnt(6)
    s_barrier
    s_waitcnt lgkmcnt(3)
    v_mfma_f32_32x32x16_bf16 v[128:143], v[208:211], v[32:35], 0
    s_add_u32 m0, s32, 49152
    s_nop 0
    buffer_load_dwordx4 v10, s[16:19], s28 offen nt lds
    buffer_load_dwordx4 v11, s[16:19], s28 offen offset:1024 nt lds
    s_add_u32 s28, s28, 16384
    ds_read_b128 v[224:227], v20 offset:0
    v_max3_f32 v1, v160, v161, v162
    v_max3_f32 v6, v176, v177, v178
    v_max3_f32 v1, v1, v163, v164
    v_max3_f32 v6, v6, v179, v180
    v_max3_f32 v1, v1, v165, v166
    s_waitcnt lgkmcnt(3)
    v_mfma_f32_32x32x16_bf16 v[128:143], v[212:215], v[36:39], v[128:143]
    s_add_u32 m0, s33, 32768
    s_nop 0
    buffer_load_dwordx4 v12, s[20:23], s29 offen nt lds
    buffer_load_dwordx4 v12, s[20:23], s29 offen offset:1024 nt lds
    s_add_u32 s29, s29, 16384
    ds_read_b128 v[228:231], v21 offset:0
    v_max3_f32 v6, v6, v181, v182
    v_max3_f32 v1, v1, v167, v168
    v_max3_f32 v6, v6, v183, v184
    v_max3_f32 v1, v1, v169, v170
    v_max3_f32 v6, v6, v185, v186
    s_waitcnt lgkmcnt(3)
    v_mfma_f32_32x32x16_bf16 v[128:143], v[216:219], v[40:43], v[128:143]
    ds_read_b128 v[208:211], v22 offset:0
    v_max3_f32 v1, v1, v171, v172
    v_max3_f32 v6, v6, v187, v188
    v_max3_f32 v1, v1, v173, v174
    v_max3_f32 v6, v6, v189, v190
    v_max3_f32 v1, v1, v175, v191
    s_waitcnt lgkmcnt(3)
    v_mfma_f32_32x32x16_bf16 v[128:143], v[220:223], v[44:47], v[128:143]
    ds_read_b128 v[212:215], v23 offset:0
    v_max_f32 v1, v1, v6
    v_mov_b32 v6, v1
    s_nop 1
    v_permlane32_swap_b32 v1, v6
    v_max_f32 v1, v1, v6
    s_waitcnt lgkmcnt(3)
    v_mfma_f32_32x32x16_bf16 v[128:143], v[224:227], v[48:51], v[128:143]
    ds_read_b128 v[216:219], v16 offset:8192
    v_fma_f32 v6, v1, s34, -v4
    v_cmp_lt_f32 vcc, s35, v6
    s_nop 4
    s_cbranch_vccnz L_rare3
L_back3:
    s_waitcnt lgkmcnt(3)
    v_mfma_f32_32x32x16_bf16 v[128:143], v[228:231], v[52:55], v[128:143]
    ds_read_b128 v[220:223], v17 offset:8192
    v_fma_f32 v160, v160, s34, -v4
    v_fma_f32 v161, v161, s34, -v4
    v_fma_f32 v162, v162, s34, -v4
    v_fma_f32 v163, v163, s34, -v4
    v_exp_f32 v160, v160
    v_exp_f32 v161, v161
    v_exp_f32 v162, v162
    s_waitcnt lgkmcnt(3)
    v_mfma_f32_32x32x16_bf16 v[128:143], v[208:211], v[56:59], v[128:143]
    ds_read_b128 v[224:227], v18 offset:8192
    v_exp_f32 v163, v163
    v_fma_f32 v164, v164, s34, -v4
    v_fma_f32 v165, v165, s34, -v4
    v_fma_f32 v166, v166, s34, -v4
    v_fma_f32 v167, v167, s34, -v4
    v_exp_f32 v164, v164
    v_exp_f32 v165, v165
    s_waitcnt lgkmcnt(3)
    v_mfma_f32_32x32x16_bf16 v[128:143], v[212:215], v[60:63], v[128:143]
    ds_read_b128 v[228:231], v19 offset:8192
    v_exp_f32 v166, v166
    v_exp_f32 v167, v167
    v_add_f32 v3, v3, v160
    v_add_f32 v3, v3, v161
    v_add_f32 v3, v3, v162
    v_add_f32 v3, v3, v163
    v_cvt_pk_bf16_f32 v192, v160, v161
    s_waitcnt lgkmcnt(3)
    v_mfma_f32_32x32x16_bf16 v[144:159], v[216:219], v[32:35], 0
    ds_read_b128 v[208:211], v20 offset:8192
    v_cvt_pk_bf16_f32 v193, v162, v163
    v_fma_f32 v168, v168, s34, -v4
    v_fma_f32 v169, v169, s34, -v4
    v_fma_f32 v170, v170, s34, -v4
    v_fma_f32 v171, v171, s34, -v4
    v_exp_f32 v168, v168
    v_exp_f32 v169, v169
    s_waitcnt lgkmcnt(3)
    v_mfma_f32_32x32x16_bf16 v[144:159], v[220:223], v[36:39], v[144:159]
    ds_read_b128 v[212:215], v21 offset:8192
    v_exp_f32 v170, v170
    v_exp_f32 v171, v171
    v_add_f32 v3, v3, v164
    v_add_f32 v3, v3, v165
    v_add_f32 v3, v3, v166
    v_add_f32 v3, v3, v167
    v_cvt_pk_bf16_f32 v194, v164, v165
    s_waitcnt lgkmcnt(3)
    v_mfma_f32_32x32x16_bf16 v[144:159], v[224:227], v[40:43], v[144:159]
    ds_read_b128 v[216:219], v22 offset:8192
    v_cvt_pk_bf16_f32 v195, v166, v167
    v_fma_f32 v172, v172, s34, -v4
    v_fma_f32 v173, v173, s34, -v4
    v_fma_f32 v174, v174, s34, -v4
    v_fma_f32 v175, v175, s34, -v4
    v_exp_f32 v172, v172
    v_exp_f32 v173, v173
    s_waitcnt lgkmcnt(3)
    v_mfma_f32_32x32x16_bf16 v[144:159], v[228:231], v[44:47], v[144:159]
    ds_read_b128 v[220:223], v23 offset:8192
    v_exp_f32 v174, v174
    v_exp_f32 v175, v175
    v_add_f32 v3, v3, v168
    v_add_f32 v3, v3, v169
    v_add_f32 v3, v3, v170
    v_add_f32 v3, v3, v171
    v_cvt_pk_bf16_f32 v196, v168, v169
    s_waitcnt lgkmcnt(3)
    v_mfma_f32_32x32x16_bf16 v[144:159], v[208:211], v[48:51], v[144:159]
    ds_read_b64_tr_b16 v[232:233], v24 offset:49152
    ds_read_b64_tr_b16 v[234:235], v24 offset:51200
    v_cvt_pk_bf16_f32 v197, v170, v171
    s_nop 0
    v_add_f32 v3, v3, v172
    v_add_f32 v3, v3, v173
    v_add_f32 v3, v3, v174
    v_add_f32 v3, v3, v175
    v_cvt_pk_bf16_f32 v198, v172, v173
    s_waitcnt lgkmcnt(4)
    v_mfma_f32_32x32x16_bf16 v[144:159], v[212:215], v[52:55], v[144:159]
    ds_read_b64_tr_b16 v[236:237], v25 offset:49152
    ds_read_b64_tr_b16 v[238:239], v25 offset:51200
    v_cvt_pk_bf16_f32 v199, v174, v175
    s_waitcnt lgkmcnt(5)
    v_mfma_f32_32x32x16_bf16 v[144:159], v[216:219], v[56:59], v[144:159]
    ds_read_b64_tr_b16 v[240:241], v26 offset:49152
    ds_read_b64_tr_b16 v[242:243], v26 offset:51200
    s_waitcnt lgkmcnt(6)
    v_mfma_f32_32x32x16_bf16 v[144:159], v[220:223], v[60:63], v[144:159]
    ds_read_b64_tr_b16 v[244:245], v27 offset:49152
    ds_read_b64_tr_b16 v[246:247], v27 offset:51200
    s_waitcnt lgkmcnt(6)
    v_mfma_f32_32x32x16_bf16 v[64:79], v[232:235], v[192:195], v[64:79]
    ds_read_b64_tr_b16 v[248:249], v24 offset:53248
    ds_read_b64_tr_b16 v[250:251], v24 offset:55296
    v_fma_f32 v176, v176, s34, -v4
    v_fma_f32 v177, v177, s34, -v4
    v_fma_f32 v178, v178, s34, -v4
    v_fma_f32 v179, v179, s34, -v4
    v_exp_f32 v176, v176
    v_exp_f32 v177, v177
    v_exp_f32 v178, v178
    v_exp_f32 v179, v179
    v_fma_f32 v180, v180, s34, -v4
    s_waitcnt lgkmcnt(6)
    v_mfma_f32_32x32x16_bf16 v[80:95], v[236:239], v[192:195], v[80:95]
    ds_read_b64_tr_b16 v[252:253], v25 offset:53248
    ds_read_b64_tr_b16 v[254:255], v25 offset:55296
    v_fma_f32 v181, v181, s34, -v4
    v_fma_f32 v182, v182, s34, -v4
    v_fma_f32 v183, v183, s34, -v4
    v_exp_f32 v180, v180
    v_exp_f32 v181, v181
    v_exp_f32 v182, v182
    v_exp_f32 v183, v183
    v_add_f32 v3, v3, v176
    v_add_f32 v3, v3, v177
    s_waitcnt lgkmcnt(6)
    v_mfma_f32_32x32x16_bf16 v[96:111], v[240:243], v[192:195], v[96:111]
    ds_read_b64_tr_b16 v[232:233], v26 offset:53248
    ds_read_b64_tr_b16 v[234:235], v26 offset:55296
    v_add_f32 v3, v3, v178
    v_add_f32 v3, v3, v179
    v_cvt_pk_bf16_f32 v200, v176, v177
    v_cvt_pk_bf16_f32 v201, v178, v179
    v_fma_f32 v184, v184, s34, -v4
    v_fma_f32 v185, v185, s34, -v4
    v_fma_f32 v186, v186, s34, -v4
    v_fma_f32 v187, v187, s34, -v4
    v_exp_f32 v184, v184
    s_waitcnt lgkmcnt(6)
    v_mfma_f32_32x32x16_bf16 v[112:127], v[244:247], v[192:195], v[112:127]
    ds_read_b64_tr_b16 v[236:237], v27 offset:53248
    ds_read_b64_tr_b16 v[238:239], v27 offset:55296
    v_exp_f32 v185, v185
    v_exp_f32 v186, v186
    v_exp_f32 v187, v187
    v_add_f32 v3, v3, v180
    v_add_f32 v3, v3, v181
    v_add_f32 v3, v3, v182
    v_add_f32 v3, v3, v183
    v_cvt_pk_bf16_f32 v202, v180, v181
    v_cvt_pk_bf16_f32 v203, v182, v183
    s_waitcnt lgkmcnt(6)
    v_mfma_f32_32x32x16_bf16 v[64:79], v[248:251], v[196:199], v[64:79]
    ds_read_b64_tr_b16 v[240:241], v24 offset:57344
    ds_read_b64_tr_b16 v[242:243], v24 offset:59392
    v_fma_f32 v188, v188, s34, -v4
    v_fma_f32 v189, v189, s34, -v4
    v_fma_f32 v190, v190, s34, -v4
    v_fma_f32 v191, v191, s34, -v4
    v_exp_f32 v188, v188
    v_exp_f32 v189, v189
    v_exp_f32 v190, v190
    v_exp_f32 v191, v191
    v_add_f32 v3, v3, v184
    s_waitcnt lgkmcnt(6)
    v_mfma_f32_32x32x16_bf16 v[80:95], v[252:255], v[196:199], v[80:95]
    ds_read_b64_tr_b16 v[244:245], v25 offset:57344
    ds_read_b64_tr_b16 v[246:247], v25 offset:59392
    v_add_f32 v3, v3, v185
    v_add_f32 v3, v3, v186
    v_add_f32 v3, v3, v187
    v_cvt_pk_bf16_f32 v204, v184, v185
    v_cvt_pk_bf16_f32 v205, v186, v187
    s_nop 0
    v_add_f32 v3, v3, v188
    v_add_f32 v3, v3, v189
    v_add_f32 v3, v3, v190
    s_waitcnt lgkmcnt(6)
    v_mfma_f32_32x32x16_bf16 v[96:111], v[232:235], v[196:199], v[96:111]
    ds_read_b64_tr_b16 v[248:249], v26 offset:57344
    ds_read_b64_tr_b16 v[250:251], v26 offset:59392
    v_add_f32 v3, v3, v191
    v_cvt_pk_bf16_f32 v206, v188, v189
    v_cvt_pk_bf16_f32 v207, v190, v191
    s_waitcnt lgkmcnt(6)
    v_mfma_f32_32x32x16_bf16 v[112:127], v[236:239], v[196:199], v[112:127]
    ds_read_b64_tr_b16 v[252:253], v27 offset:57344
    ds_read_b64_tr_b16 v[254:255], v27 offset:59392
    s_nop 1
    s_waitcnt lgkmcnt(6)
    v_mfma_f32_32x32x16_bf16 v[64:79], v[240:243], v[200:203], v[64:79]
    ds_read_b64_tr_b16 v[232:233], v24 offset:61440
    ds_read_b64_tr_b16 v[234:235], v24 offset:63488
    s_waitcnt lgkmcnt(6)
    v_mfma_f32_32x32x16_bf16 v[80:95], v[244:247], v[200:203], v[80:95]
    ds_read_b64_tr_b16 v[236:237], v25 offset:61440
    ds_read_b64_tr_b16 v[238:239], v25 offset:63488
    s_waitcnt lgkmcnt(6)
    v_mfma_f32_32x32x16_bf16 v[96:111], v[248:251], v[200:203], v[96:111]
    ds_read_b64_tr_b16 v[240:241], v26 offset:61440
    ds_read_b64_tr_b16 v[242:243], v26 offset:63488
    s_waitcnt lgkmcnt(6)
    v_mfma_f32_32x32x16_bf16 v[112:127], v[252:255], v[200:203], v[112:127]
    ds_read_b64_tr_b16 v[244:245], v27 offset:61440
    ds_read_b64_tr_b16 v[246:247], v27 offset:63488
    s_waitcnt lgkmcnt(6)
    v_mfma_f32_32x32x16_bf16 v[64:79], v[232:235], v[204:207], v[64:79]
    ds_read_b128 v[208:211], v16 offset:16384
    s_waitcnt lgkmcnt(5)
    v_mfma_f32_32x32x16_bf16 v[80:95], v[236:239], v[204:207], v[80:95]
    ds_read_b128 v[212:215], v17 offset:16384
    s_waitcnt lgkmcnt(4)
    v_mfma_f32_32x32x16_bf16 v[96:111], v[240:243], v[204:207], v[96:111]
    ds_read_b128 v[216:219], v18 offset:16384
    s_waitcnt lgkmcnt(3)
    v_mfma_f32_32x32x16_bf16 v[112:127], v[244:247], v[204:207], v[112:127]
    ds_read_b128 v[220:223], v19 offset:16384
    s_add_u32 s30, s30, 1
    s_cmp_lt_u32 s30, 3
    s_cbranch_scc1 L_loop
    s_waitcnt vmcnt(6)
    s_barrier
    s_waitcnt lgkmcnt(3)
    v_mfma_f32_32x32x16_bf16 v[160:175], v[208:211], v[32:35], 0
    ds_read_b128 v[224:227], v20 offset:16384
    v_max3_f32 v1, v128, v129, v130
    v_max3_f32 v6, v144, v145, v146
    v_max3_f32 v1, v1, v131, v132
    v_max3_f32 v6, v6, v147, v148
    v_max3_f32 v1, v1, v133, v134
    s_waitcnt lgkmcnt(3)
    v_mfma_f32_32x32x16_bf16 v[160:175], v[212:215], v[36:39], v[160:175]
    s_add_u32 m0, s33, 49152
    s_nop 0
    buffer_load_dwordx4 v12, s[20:23], s29 offen nt lds
    buffer_load_dwordx4 v12, s[20:23], s29 offen offset:1024 nt lds
    s_add_u32 s29, s29, 16384
    ds_read_b128 v[228:231], v21 offset:16384
    v_max3_f32 v6, v6, v149, v150
    v_max3_f32 v1, v1, v135, v136
    v_max3_f32 v6, v6, v151, v152
    v_max3_f32 v1, v1, v137, v138
    v_max3_f32 v6, v6, v153, v154
    s_waitcnt lgkmcnt(3)
    v_mfma_f32_32x32x16_bf16 v[160:175], v[216:219], v[40:43], v[160:175]
    ds_read_b128 v[208:211], v22 offset:16384
    v_max3_f32 v1, v1, v139, v140
    v_max3_f32 v6, v6, v155, v156
    v_max3_f32 v1, v1, v141, v142
    v_max3_f32 v6, v6, v157, v158
    v_max3_f32 v1, v1, v143, v159
    s_waitcnt lgkmcnt(3)
    v_mfma_f32_32x32x16_bf16 v[160:175], v[220:223], v[44:47], v[160:175]
    ds_read_b128 v[212:215], v23 offset:16384
    v_max_f32 v1, v1, v6
    v_mov_b32 v6, v1
    s_nop 1
    v_permlane32_swap_b32 v1, v6
    v_max_f32 v1, v1, v6
    s_waitcnt lgkmcnt(3)
    v_mfma_f32_32x32x16_bf16 v[160:175], v[224:227], v[48:51], v[160:175]
    ds_read_b128 v[216:219], v16 offset:24576
    v_fma_f32 v6, v1, s34, -v4
    v_cmp_lt_f32 vcc, s35, v6
    s_nop 4
    s_cbranch_vccnz L_rare12
L_back12:
    s_waitcnt lgkmcnt(3)
    v_mfma_f32_32x32x16_bf16 v[160:175], v[228:231], v[52:55], v[160:175]
    ds_read_b128 v[220:223], v17 offset:24576
    v_fma_f32 v128, v128, s34, -v4
    v_fma_f32 v129, v129, s34, -v4
    v_fma_f32 v130, v130, s34, -v4
    v_fma_f32 v131, v131, s34, -v4
    v_exp_f32 v128, v128
    v_exp_f32 v129, v129
    v_exp_f32 v130, v130
    s_waitcnt lgkmcnt(3)
    v_mfma_f32_32x32x16_bf16 v[160:175], v[208:211], v[56:59], v[160:175]
    ds_read_b128 v[224:227], v18 offset:24576
    v_exp_f32 v131, v131
    v_fma_f32 v132, v132, s34, -v4
    v_fma_f32 v133, v133, s34, -v4
    v_fma_f32 v134, v134, s34, -v4
    v_fma_f32 v135, v135, s34, -v4
    v_exp_f32 v132, v132
    v_exp_f32 v133, v133
    s_waitcnt lgkmcnt(3)
    v_mfma_f32_32x32x16_bf16 v[160:175], v[212:215], v[60:63], v[160:175]
    ds_read_b128 v[228:231], v19 offset:24576
    v_exp_f32 v134, v134
    v_exp_f32 v135, v135
    v_add_f32 v3, v3, v128
    v_add_f32 v3, v3, v129
    v_add_f32 v3, v3, v130
    v_add_f32 v3, v3, v131
    v_cvt_pk_bf16_f32 v192, v128, v129
    s_waitcnt lgkmcnt(3)
    v_mfma_f32_32x32x16_bf16 v[176:191], v[216:219], v[32:35], 0
    ds_read_b128 v[208:211], v20 offset:24576
    v_cvt_pk_bf16_f32 v193, v130, v131
    v_fma_f32 v136, v136, s34, -v4
    v_fma_f32 v137, v137, s34, -v4
    v_fma_f32 v138, v138, s34, -v4
    v_fma_f32 v139, v139, s34, -v4
    v_exp_f32 v136, v136
    v_exp_f32 v137, v137
    s_waitcnt lgkmcnt(3)
    v_mfma_f32_32x32x16_bf16 v[176:191], v[220:223], v[36:39], v[176:191]
    ds_read_b128 v[212:215], v21 offset:24576
    v_exp_f32 v138, v138
    v_exp_f32 v139, v139
    v_add_f32 v3, v3, v132
    v_add_f32 v3, v3, v133
    v_add_f32 v3, v3, v134
    v_add_f32 v3, v3, v135
    v_cvt_pk_bf16_f32 v194, v132, v133
    s_waitcnt lgkmcnt(3)
    v_mfma_f32_32x32x16_bf16 v[176:191], v[224:227], v[40:43], v[176:191]
    ds_read_b128 v[216:219], v22 offset:24576
    v_cvt_pk_bf16_f32 v195, v134, v135
    v_fma_f32 v140, v140, s34, -v4
    v_fma_f32 v141, v141, s34, -v4
    v_fma_f32 v142, v142, s34, -v4
    v_fma_f32 v143, v143, s34, -v4
    v_exp_f32 v140, v140
    v_exp_f32 v141, v141
    s_waitcnt lgkmcnt(3)
    v_mfma_f32_32x32x16_bf16 v[176:191], v[228:231], v[44:47], v[176:191]
    ds_read_b128 v[220:223], v23 offset:24576
    v_exp_f32 v142, v142
    v_exp_f32 v143, v143
    v_add_f32 v3, v3, v136
    v_add_f32 v3, v3, v137
    v_add_f32 v3, v3, v138
    v_add_f32 v3, v3, v139
    v_cvt_pk_bf16_f32 v196, v136, v137
    s_waitcnt lgkmcnt(3)
    v_mfma_f32_32x32x16_bf16 v[176:191], v[208:211], v[48:51], v[176:191]
    ds_read_b64_tr_b16 v[232:233], v24 offset:0
    ds_read_b64_tr_b16 v[234:235], v24 offset:2048
    v_cvt_pk_bf16_f32 v197, v138, v139
    s_nop 0
    v_add_f32 v3, v3, v140
    v_add_f32 v3, v3, v141
    v_add_f32 v3, v3, v142
    v_add_f32 v3, v3, v143
    v_cvt_pk_bf16_f32 v198, v140, v141
    s_waitcnt lgkmcnt(4)
    v_mfma_f32_32x32x16_bf16 v[176:191], v[212:215], v[52:55], v[176:191]
    ds_read_b64_tr_b16 v[236:237], v25 offset:0
    ds_read_b64_tr_b16 v[238:239], v25 offset:2048
    v_cvt_pk_bf16_f32 v199, v142, v143
    s_waitcnt lgkmcnt(5)
    v_mfma_f32_32x32x16_bf16 v[176:191], v[216:219], v[56:59], v[176:191]
    ds_read_b64_tr_b16 v[240:241], v26 offset:0
    ds_read_b64_tr_b16 v[242:243], v26 offset:2048
    s_waitcnt lgkmcnt(6)
    v_mfma_f32_32x32x16_bf16 v[176:191], v[220:223], v[60:63], v[176:191]
    ds_read_b64_tr_b16 v[244:245], v27 offset:0
    ds_read_b64_tr_b16 v[246:247], v27 offset:2048
    s_waitcnt lgkmcnt(6)
    v_mfma_f32_32x32x16_bf16 v[64:79], v[232:235], v[192:195], v[64:79]
    ds_read_b64_tr_b16 v[248:249], v24 offset:4096
    ds_read_b64_tr_b16 v[250:251], v24 offset:6144
    v_fma_f32 v144, v144, s34, -v4
    v_fma_f32 v145, v145, s34, -v4
    v_fma_f32 v146, v146, s34, -v4
    v_fma_f32 v147, v147, s34, -v4
    v_exp_f32 v144, v144
    v_exp_f32 v145, v145
    v_exp_f32 v146, v146
    v_exp_f32 v147, v147
    v_fma_f32 v148, v148, s34, -v4
    s_waitcnt lgkmcnt(6)
    v_mfma_f32_32x32x16_bf16 v[80:95], v[236:239], v[192:195], v[80:95]
    ds_read_b64_tr_b16 v[252:253], v25 offset:4096
    ds_read_b64_tr_b16 v[254:255], v25 offset:6144
    v_fma_f32 v149, v149, s34, -v4
    v_fma_f32 v150, v150, s34, -v4
    v_fma_f32 v151, v151, s34, -v4
    v_exp_f32 v148, v148
    v_exp_f32 v149, v149
    v_exp_f32 v150, v150
    v_exp_f32 v151, v151
    v_add_f32 v3, v3, v144
    v_add_f32 v3, v3, v145
    s_waitcnt lgkmcnt(6)
    v_mfma_f32_32x32x16_bf16 v[96:111], v[240:243], v[192:195], v[96:111]
    ds_read_b64_tr_b16 v[232:233], v26 offset:4096
    ds_read_b64_tr_b16 v[234:235], v26 offset:6144
    v_add_f32 v3, v3, v146
    v_add_f32 v3, v3, v147
    v_cvt_pk_bf16_f32 v200, v144, v145
    v_cvt_pk_bf16_f32 v201, v146, v147
    v_fma_f32 v152, v152, s34, -v4
    v_fma_f32 v153, v153, s34, -v4
    v_fma_f32 v154, v154, s34, -v4
    v_fma_f32 v155, v155, s34, -v4
    v_exp_f32 v152, v152
    s_waitcnt lgkmcnt(6)
    v_mfma_f32_32x32x16_bf16 v[112:127], v[244:247], v[192:195], v[112:127]
    ds_read_b64_tr_b16 v[236:237], v27 offset:4096
    ds_read_b64_tr_b16 v[238:239], v27 offset:6144
    v_exp_f32 v153, v153
    v_exp_f32 v154, v154
    v_exp_f32 v155, v155
    v_add_f32 v3, v3, v148
    v_add_f32 v3, v3, v149
    v_add_f32 v3, v3, v150
    v_add_f32 v3, v3, v151
    v_cvt_pk_bf16_f32 v202, v148, v149
    v_cvt_pk_bf16_f32 v203, v150, v151
    s_waitcnt lgkmcnt(6)
    v_mfma_f32_32x32x16_bf16 v[64:79], v[248:251], v[196:199], v[64:79]
    ds_read_b64_tr_b16 v[240:241], v24 offset:8192
    ds_read_b64_tr_b16 v[242:243], v24 offset:10240
    v_fma_f32 v156, v156, s34, -v4
    v_fma_f32 v157, v157, s34, -v4
    v_fma_f32 v158, v158, s34, -v4
    v_fma_f32 v159, v159, s34, -v4
    v_exp_f32 v156, v156
    v_exp_f32 v157, v157
    v_exp_f32 v158, v158
    v_exp_f32 v159, v159
    v_add_f32 v3, v3, v152
    s_waitcnt lgkmcnt(6)
    v_mfma_f32_32x32x16_bf16 v[80:95], v[252:255], v[196:199], v[80:95]
    ds_read_b64_tr_b16 v[244:245], v25 offset:8192
    ds_read_b64_tr_b16 v[246:247], v25 offset:10240
    v_add_f32 v3, v3, v153
    v_add_f32 v3, v3, v154
    v_add_f32 v3, v3, v155
    v_cvt_pk_bf16_f32 v204, v152, v153
    v_cvt_pk_bf16_f32 v205, v154, v155
    s_nop 0
    v_add_f32 v3, v3, v156
    v_add_f32 v3, v3, v157
    v_add_f32 v3, v3, v158
    s_waitcnt lgkmcnt(6)
    v_mfma_f32_32x32x16_bf16 v[96:111], v[232:235], v[196:199], v[96:111]
    ds_read_b64_tr_b16 v[248:249], v26 offset:8192
    ds_read_b64_tr_b16 v[250:251], v26 offset:10240
    v_add_f32 v3, v3, v159
    v_cvt_pk_bf16_f32 v206, v156, v157
    v_cvt_pk_bf16_f32 v207, v158, v159
    s_waitcnt lgkmcnt(6)
    v_mfma_f32_32x32x16_bf16 v[112:127], v[236:239], v[196:199], v[112:127]
    ds_read_b64_tr_b16 v[252:253], v27 offset:8192
    ds_read_b64_tr_b16 v[254:255], v27 offset:10240
    s_nop 1
    s_waitcnt lgkmcnt(6)
    v_mfma_f32_32x32x16_bf16 v[64:79], v[240:243], v[200:203], v[64:79]
    ds_read_b64_tr_b16 v[232:233], v24 offset:12288
    ds_read_b64_tr_b16 v[234:235], v24 offset:14336
    s_waitcnt lgkmcnt(6)
    v_mfma_f32_32x32x16_bf16 v[80:95], v[244:247], v[200:203], v[80:95]
    ds_read_b64_tr_b16 v[236:237], v25 offset:12288
    ds_read_b64_tr_b16 v[238:239], v25 offset:14336
    s_waitcnt lgkmcnt(6)
    v_mfma_f32_32x32x16_bf16 v[96:111], v[248:251], v[200:203], v[96:111]
    ds_read_b64_tr_b16 v[240:241], v26 offset:12288
    ds_read_b64_tr_b16 v[242:243], v26 offset:14336
    s_waitcnt lgkmcnt(6)
    v_mfma_f32_32x32x16_bf16 v[112:127], v[252:255], v[200:203], v[112:127]
    ds_read_b64_tr_b16 v[244:245], v27 offset:12288
    ds_read_b64_tr_b16 v[246:247], v27 offset:14336
    s_waitcnt lgkmcnt(6)
    v_mfma_f32_32x32x16_bf16 v[64:79], v[232:235], v[204:207], v[64:79]
    ds_read_b128 v[208:211], v16 offset:32768
    s_waitcnt lgkmcnt(5)
    v_mfma_f32_32x32x16_bf16 v[80:95], v[236:239], v[204:207], v[80:95]
    ds_read_b128 v[212:215], v17 offset:32768
    s_waitcnt lgkmcnt(4)
    v_mfma_f32_32x32x16_bf16 v[96:111], v[240:243], v[204:207], v[96:111]
    ds_read_b128 v[216:219], v18 offset:32768
    s_waitcnt lgkmcnt(3)
    v_mfma_f32_32x32x16_bf16 v[112:127], v[244:247], v[204:207], v[112:127]
    ds_read_b128 v[220:223], v19 offset:32768
    s_waitcnt vmcnt(4)
    s_barrier
    s_waitcnt lgkmcnt(3)
    v_mfma_f32_32x32x16_bf16 v[128:143], v[208:211], v[32:35], 0
    ds_read_b128 v[224:227], v20 offset:32768
    v_max3_f32 v1, v160, v161, v162
    v_max3_f32 v6, v176, v177, v178
    v_max3_f32 v1, v1, v163, v164
    v_max3_f32 v6, v6, v179, v180
    v_max3_f32 v1, v1, v165, v166
    s_waitcnt lgkmcnt(3)
    v_mfma_f32_32x32x16_bf16 v[128:143], v[212:215], v[36:39], v[128:143]
    ds_read_b128 v[228:231], v21 offset:32768
    v_max3_f32 v6, v6, v181, v182
    v_max3_f32 v1, v1, v167, v168
    v_max3_f32 v6, v6, v183, v184
    v_max3_f32 v1, v1, v169, v170
    v_max3_f32 v6, v6, v185, v186
    s_waitcnt lgkmcnt(3)
    v_mfma_f32_32x32x16_bf16 v[128:143], v[216:219], v[40:43], v[128:143]
    ds_read_b128 v[208:211], v22 offset:32768
    v_max3_f32 v1, v1, v171, v172
    v_max3_f32 v6, v6, v187, v188
    v_max3_f32 v1, v1, v173, v174
    v_max3_f32 v6, v6, v189, v190
    v_max3_f32 v1, v1, v175, v191
    s_waitcnt lgkmcnt(3)
    v_mfma_f32_32x32x16_bf16 v[128:143], v[220:223], v[44:47], v[128:143]
    ds_read_b128 v[212:215], v23 offset:32768
    v_max_f32 v1, v1, v6
    v_mov_b32 v6, v1
    s_nop 1
    v_permlane32_swap_b32 v1, v6
    v_max_f32 v1, v1, v6
    s_waitcnt lgkmcnt(3)
    v_mfma_f32_32x32x16_bf16 v[128:143], v[224:227], v[48:51], v[128:143]
    ds_read_b128 v[216:219], v16 offset:40960
    v_fma_f32 v6, v1, s34, -v4
    v_cmp_lt_f32 vcc, s35, v6
    s_nop 4
    s_cbranch_vccnz L_rare13
L_back13:
    s_waitcnt lgkmcnt(3)
    v_mfma_f32_32x32x16_bf16 v[128:143], v[228:231], v[52:55], v[128:143]
    ds_read_b128 v[220:223], v17 offset:40960
    v_fma_f32 v160, v160, s34, -v4
    v_fma_f32 v161, v161, s34, -v4
    v_fma_f32 v162, v162, s34, -v4
    v_fma_f32 v163, v163, s34, -v4
    v_exp_f32 v160, v160
    v_exp_f32 v161, v161
    v_exp_f32 v162, v162
    s_waitcnt lgkmcnt(3)
    v_mfma_f32_32x32x16_bf16 v[128:143], v[208:211], v[56:59], v[128:143]
    ds_read_b128 v[224:227], v18 offset:40960
    v_exp_f32 v163, v163
    v_fma_f32 v164, v164, s34, -v4
    v_fma_f32 v165, v165, s34, -v4
    v_fma_f32 v166, v166, s34, -v4
    v_fma_f32 v167, v167, s34, -v4
    v_exp_f32 v164, v164
    v_exp_f32 v165, v165
    s_waitcnt lgkmcnt(3)
    v_mfma_f32_32x32x16_bf16 v[128:143], v[212:215], v[60:63], v[128:143]
    ds_read_b128 v[228:231], v19 offset:40960
    v_exp_f32 v166, v166
    v_exp_f32 v167, v167
    v_add_f32 v3, v3, v160
    v_add_f32 v3, v3, v161
    v_add_f32 v3, v3, v162
    v_add_f32 v3, v3, v163
    v_cvt_pk_bf16_f32 v192, v160, v161
    s_waitcnt lgkmcnt(3)
    v_mfma_f32_32x32x16_bf16 v[144:159], v[216:219], v[32:35], 0
    ds_read_b128 v[208:211], v20 offset:40960
    v_cvt_pk_bf16_f32 v193, v162, v163
    v_fma_f32 v168, v168, s34, -v4
    v_fma_f32 v169, v169, s34, -v4
    v_fma_f32 v170, v170, s34, -v4
    v_fma_f32 v171, v171, s34, -v4
    v_exp_f32 v168, v168
    v_exp_f32 v169, v169
    s_waitcnt lgkmcnt(3)
    v_mfma_f32_32x32x16_bf16 v[144:159], v[220:223], v[36:39], v[144:159]
    ds_read_b128 v[212:215], v21 offset:40960
    v_exp_f32 v170, v170
    v_exp_f32 v171, v171
    v_add_f32 v3, v3, v164
    v_add_f32 v3, v3, v165
    v_add_f32 v3, v3, v166
    v_add_f32 v3, v3, v167
    v_cvt_pk_bf16_f32 v194, v164, v165
    s_waitcnt lgkmcnt(3)
    v_mfma_f32_32x32x16_bf16 v[144:159], v[224:227], v[40:43], v[144:159]
    ds_read_b128 v[216:219], v22 offset:40960
    v_cvt_pk_bf16_f32 v195, v166, v167
    v_fma_f32 v172, v172, s34, -v4
    v_fma_f32 v173, v173, s34, -v4
    v_fma_f32 v174, v174, s34, -v4
    v_fma_f32 v175, v175, s34, -v4
    v_exp_f32 v172, v172
    v_exp_f32 v173, v173
    s_waitcnt lgkmcnt(3)
    v_mfma_f32_32x32x16_bf16 v[144:159], v[228:231], v[44:47], v[144:159]
    ds_read_b128 v[220:223], v23 offset:40960
    v_exp_f32 v174, v174
    v_exp_f32 v175, v175
    v_add_f32 v3, v3, v168
    v_add_f32 v3, v3, v169
    v_add_f32 v3, v3, v170
    v_add_f32 v3, v3, v171
    v_cvt_pk_bf16_f32 v196, v168, v169
    s_waitcnt lgkmcnt(3)
    v_mfma_f32_32x32x16_bf16 v[144:159], v[208:211], v[48:51], v[144:159]
    ds_read_b64_tr_b16 v[232:233], v24 offset:16384
    ds_read_b64_tr_b16 v[234:235], v24 offset:18432
    v_cvt_pk_bf16_f32 v197, v170, v171
    s_nop 0
    v_add_f32 v3, v3, v172
    v_add_f32 v3, v3, v173
    v_add_f32 v3, v3, v174
    v_add_f32 v3, v3, v175
    v_cvt_pk_bf16_f32 v198, v172, v173
    s_waitcnt lgkmcnt(4)
    v_mfma_f32_32x32x16_bf16 v[144:159], v[212:215], v[52:55], v[144:159]
    ds_read_b64_tr_b16 v[236:237], v25 offset:16384
    ds_read_b64_tr_b16 v[238:239], v25 offset:18432
    v_cvt_pk_bf16_f32 v199, v174, v175
    s_waitcnt lgkmcnt(5)
    v_mfma_f32_32x32x16_bf16 v[144:159], v[216:219], v[56:59], v[144:159]
    ds_read_b64_tr_b16 v[240:241], v26 offset:16384
    ds_read_b64_tr_b16 v[242:243], v26 offset:18432
    s_waitcnt lgkmcnt(6)
    v_mfma_f32_32x32x16_bf16 v[144:159], v[220:223], v[60:63], v[144:159]
    ds_read_b64_tr_b16 v[244:245], v27 offset:16384
    ds_read_b64_tr_b16 v[246:247], v27 offset:18432
    s_waitcnt lgkmcnt(6)
    v_mfma_f32_32x32x16_bf16 v[64:79], v[232:235], v[192:195], v[64:79]
    ds_read_b64_tr_b16 v[248:249], v24 offset:20480
    ds_read_b64_tr_b16 v[250:251], v24 offset:22528
    v_fma_f32 v176, v176, s34, -v4
    v_fma_f32 v177, v177, s34, -v4
    v_fma_f32 v178, v178, s34, -v4
    v_fma_f32 v179, v179, s34, -v4
    v_exp_f32 v176, v176
    v_exp_f32 v177, v177
    v_exp_f32 v178, v178
    v_exp_f32 v179, v179
    v_fma_f32 v180, v180, s34, -v4
    s_waitcnt lgkmcnt(6)
    v_mfma_f32_32x32x16_bf16 v[80:95], v[236:239], v[192:195], v[80:95]
    ds_read_b64_tr_b16 v[252:253], v25 offset:20480
    ds_read_b64_tr_b16 v[254:255], v25 offset:22528
    v_fma_f32 v181, v181, s34, -v4
    v_fma_f32 v182, v182, s34, -v4
    v_fma_f32 v183, v183, s34, -v4
    v_exp_f32 v180, v180
    v_exp_f32 v181, v181
    v_exp_f32 v182, v182
    v_exp_f32 v183, v183
    v_add_f32 v3, v3, v176
    v_add_f32 v3, v3, v177
    s_waitcnt lgkmcnt(6)
    v_mfma_f32_32x32x16_bf16 v[96:111], v[240:243], v[192:195], v[96:111]
    ds_read_b64_tr_b16 v[232:233], v26 offset:20480
    ds_read_b64_tr_b16 v[234:235], v26 offset:22528
    v_add_f32 v3, v3, v178
    v_add_f32 v3, v3, v179
    v_cvt_pk_bf16_f32 v200, v176, v177
    v_cvt_pk_bf16_f32 v201, v178, v179
    v_fma_f32 v184, v184, s34, -v4
    v_fma_f32 v185, v185, s34, -v4
    v_fma_f32 v186, v186, s34, -v4
    v_fma_f32 v187, v187, s34, -v4
    v_exp_f32 v184, v184
    s_waitcnt lgkmcnt(6)
    v_mfma_f32_32x32x16_bf16 v[112:127], v[244:247], v[192:195], v[112:127]
    ds_read_b64_tr_b16 v[236:237], v27 offset:20480
    ds_read_b64_tr_b16 v[238:239], v27 offset:22528
    v_exp_f32 v185, v185
    v_exp_f32 v186, v186
    v_exp_f32 v187, v187
    v_add_f32 v3, v3, v180
    v_add_f32 v3, v3, v181
    v_add_f32 v3, v3, v182
    v_add_f32 v3, v3, v183
    v_cvt_pk_bf16_f32 v202, v180, v181
    v_cvt_pk_bf16_f32 v203, v182, v183
    s_waitcnt lgkmcnt(6)
    v_mfma_f32_32x32x16_bf16 v[64:79], v[248:251], v[196:199], v[64:79]
    ds_read_b64_tr_b16 v[240:241], v24 offset:24576
    ds_read_b64_tr_b16 v[242:243], v24 offset:26624
    v_fma_f32 v188, v188, s34, -v4
    v_fma_f32 v189, v189, s34, -v4
    v_fma_f32 v190, v190, s34, -v4
    v_fma_f32 v191, v191, s34, -v4
    v_exp_f32 v188, v188
    v_exp_f32 v189, v189
    v_exp_f32 v190, v190
    v_exp_f32 v191, v191
    v_add_f32 v3, v3, v184
    s_waitcnt lgkmcnt(6)
    v_mfma_f32_32x32x16_bf16 v[80:95], v[252:255], v[196:199], v[80:95]
    ds_read_b64_tr_b16 v[244:245], v25 offset:24576
    ds_read_b64_tr_b16 v[246:247], v25 offset:26624
    v_add_f32 v3, v3, v185
    v_add_f32 v3, v3, v186
    v_add_f32 v3, v3, v187
    v_cvt_pk_bf16_f32 v204, v184, v185
    v_cvt_pk_bf16_f32 v205, v186, v187
    s_nop 0
    v_add_f32 v3, v3, v188
    v_add_f32 v3, v3, v189
    v_add_f32 v3, v3, v190
    s_waitcnt lgkmcnt(6)
    v_mfma_f32_32x32x16_bf16 v[96:111], v[232:235], v[196:199], v[96:111]
    ds_read_b64_tr_b16 v[248:249], v26 offset:24576
    ds_read_b64_tr_b16 v[250:251], v26 offset:26624
    v_add_f32 v3, v3, v191
    v_cvt_pk_bf16_f32 v206, v188, v189
    v_cvt_pk_bf16_f32 v207, v190, v191
    s_waitcnt lgkmcnt(6)
    v_mfma_f32_32x32x16_bf16 v[112:127], v[236:239], v[196:199], v[112:127]
    ds_read_b64_tr_b16 v[252:253], v27 offset:24576
    ds_read_b64_tr_b16 v[254:255], v27 offset:26624
    s_nop 1
    s_waitcnt lgkmcnt(6)
    v_mfma_f32_32x32x16_bf16 v[64:79], v[240:243], v[200:203], v[64:79]
    ds_read_b64_tr_b16 v[232:233], v24 offset:28672
    ds_read_b64_tr_b16 v[234:235], v24 offset:30720
    s_waitcnt lgkmcnt(6)
    v_mfma_f32_32x32x16_bf16 v[80:95], v[244:247], v[200:203], v[80:95]
    ds_read_b64_tr_b16 v[236:237], v25 offset:28672
    ds_read_b64_tr_b16 v[238:239], v25 offset:30720
    s_waitcnt lgkmcnt(6)
    v_mfma_f32_32x32x16_bf16 v[96:111], v[248:251], v[200:203], v[96:111]
    ds_read_b64_tr_b16 v[240:241], v26 offset:28672
    ds_read_b64_tr_b16 v[242:243], v26 offset:30720
    s_waitcnt lgkmcnt(6)
    v_mfma_f32_32x32x16_bf16 v[112:127], v[252:255], v[200:203], v[112:127]
    ds_read_b64_tr_b16 v[244:245], v27 offset:28672
    ds_read_b64_tr_b16 v[246:247], v27 offset:30720
    s_waitcnt lgkmcnt(6)
    v_mfma_f32_32x32x16_bf16 v[64:79], v[232:235], v[204:207], v[64:79]
    ds_read_b128 v[208:211], v16 offset:49152
    s_waitcnt lgkmcnt(5)
    v_mfma_f32_32x32x16_bf16 v[80:95], v[236:239], v[204:207], v[80:95]
    ds_read_b128 v[212:215], v17 offset:49152
    s_waitcnt lgkmcnt(4)
    v_mfma_f32_32x32x16_bf16 v[96:111], v[240:243], v[204:207], v[96:111]
    ds_read_b128 v[216:219], v18 offset:49152
    s_waitcnt lgkmcnt(3)
    v_mfma_f32_32x32x16_bf16 v[112:127], v[244:247], v[204:207], v[112:127]
    ds_read_b128 v[220:223], v19 offset:49152
    s_waitcnt vmcnt(2)
    s_barrier
    s_waitcnt lgkmcnt(3)
    v_mfma_f32_32x32x16_bf16 v[160:175], v[208:211], v[32:35], 0
    ds_read_b128 v[224:227], v20 offset:49152
    v_max3_f32 v1, v128, v129, v130
    v_max3_f32 v6, v144, v145, v146
    v_max3_f32 v1, v1, v131, v132
    v_max3_f32 v6, v6, v147, v148
    v_max3_f32 v1, v1, v133, v134
    s_waitcnt lgkmcnt(3)
    v_mfma_f32_32x32x16_bf16 v[160:175], v[212:215], v[36:39], v[160:175]
    ds_read_b128 v[228:231], v21 offset:49152
    v_max3_f32 v6, v6, v149, v150
    v_max3_f32 v1, v1, v135, v136
    v_max3_f32 v6, v6, v151, v152
    v_max3_f32 v1, v1, v137, v138
    v_max3_f32 v6, v6, v153, v154
    s_waitcnt lgkmcnt(3)
    v_mfma_f32_32x32x16_bf16 v[160:175], v[216:219], v[40:43], v[160:175]
    ds_read_b128 v[208:211], v22 offset:49152
    v_max3_f32 v1, v1, v139, v140
    v_max3_f32 v6, v6, v155, v156
    v_max3_f32 v1, v1, v141, v142
    v_max3_f32 v6, v6, v157, v158
    v_max3_f32 v1, v1, v143, v159
    s_waitcnt lgkmcnt(3)
    v_mfma_f32_32x32x16_bf16 v[160:175], v[220:223], v[44:47], v[160:175]
    ds_read_b128 v[212:215], v23 offset:49152
    v_max_f32 v1, v1, v6
    v_mov_b32 v6, v1
    s_nop 1
    v_permlane32_swap_b32 v1, v6
    v_max_f32 v1, v1, v6
    s_waitcnt lgkmcnt(3)
    v_mfma_f32_32x32x16_bf16 v[160:175], v[224:227], v[48:51], v[160:175]
    ds_read_b128 v[216:219], v16 offset:57344
    v_fma_f32 v6, v1, s34, -v4
    v_cmp_lt_f32 vcc, s35, v6
    s_nop 4
    s_cbranch_vccnz L_rare14
L_back14:
    s_waitcnt lgkmcnt(3)
    v_mfma_f32_32x32x16_bf16 v[160:175], v[228:231], v[52:55], v[160:175]
    ds_read_b128 v[220:223], v17 offset:57344
    v_fma_f32 v128, v128, s34, -v4
    v_fma_f32 v129, v129, s34, -v4
    v_fma_f32 v130, v130, s34, -v4
    v_fma_f32 v131, v131, s34, -v4
    v_exp_f32 v128, v128
    v_exp_f32 v129, v129
    v_exp_f32 v130, v130
    s_waitcnt lgkmcnt(3)
    v_mfma_f32_32x32x16_bf16 v[160:175], v[208:211], v[56:59], v[160:175]
    ds_read_b128 v[224:227], v18 offset:57344
    v_exp_f32 v131, v131
    v_fma_f32 v132, v132, s34, -v4
    v_fma_f32 v133, v133, s34, -v4
    v_fma_f32 v134, v134, s34, -v4
    v_fma_f32 v135, v135, s34, -v4
    v_exp_f32 v132, v132
    v_exp_f32 v133, v133
    s_waitcnt lgkmcnt(3)
    v_mfma_f32_32x32x16_bf16 v[160:175], v[212:215], v[60:63], v[160:175]
    ds_read_b128 v[228:231], v19 offset:57344
    v_exp_f32 v134, v134
    v_exp_f32 v135, v135
    v_add_f32 v3, v3, v128
    v_add_f32 v3, v3, v129
    v_add_f32 v3, v3, v130
    v_add_f32 v3, v3, v131
    v_cvt_pk_bf16_f32 v192, v128, v129
    s_waitcnt lgkmcnt(3)
    v_mfma_f32_32x32x16_bf16 v[176:191], v[216:219], v[32:35], 0
    ds_read_b128 v[208:211], v20 offset:57344
    v_cvt_pk_bf16_f32 v193, v130, v131
    v_fma_f32 v136, v136, s34, -v4
    v_fma_f32 v137, v137, s34, -v4
    v_fma_f32 v138, v138, s34, -v4
    v_fma_f32 v139, v139, s34, -v4
    v_exp_f32 v136, v136
    v_exp_f32 v137, v137
    s_waitcnt lgkmcnt(3)
    v_mfma_f32_32x32x16_bf16 v[176:191], v[220:223], v[36:39], v[176:191]
    ds_read_b128 v[212:215], v21 offset:57344
    v_exp_f32 v138, v138
    v_exp_f32 v139, v139
    v_add_f32 v3, v3, v132
    v_add_f32 v3, v3, v133
    v_add_f32 v3, v3, v134
    v_add_f32 v3, v3, v135
    v_cvt_pk_bf16_f32 v194, v132, v133
    s_waitcnt lgkmcnt(3)
    v_mfma_f32_32x32x16_bf16 v[176:191], v[224:227], v[40:43], v[176:191]
    ds_read_b128 v[216:219], v22 offset:57344
    v_cvt_pk_bf16_f32 v195, v134, v135
    v_fma_f32 v140, v140, s34, -v4
    v_fma_f32 v141, v141, s34, -v4
    v_fma_f32 v142, v142, s34, -v4
    v_fma_f32 v143, v143, s34, -v4
    v_exp_f32 v140, v140
    v_exp_f32 v141, v141
    s_waitcnt lgkmcnt(3)
    v_mfma_f32_32x32x16_bf16 v[176:191], v[228:231], v[44:47], v[176:191]
    ds_read_b128 v[220:223], v23 offset:57344
    v_exp_f32 v142, v142
    v_exp_f32 v143, v143
    v_add_f32 v3, v3, v136
    v_add_f32 v3, v3, v137
    v_add_f32 v3, v3, v138
    v_add_f32 v3, v3, v139
    v_cvt_pk_bf16_f32 v196, v136, v137
    s_waitcnt lgkmcnt(3)
    v_mfma_f32_32x32x16_bf16 v[176:191], v[208:211], v[48:51], v[176:191]
    ds_read_b64_tr_b16 v[232:233], v24 offset:32768
    ds_read_b64_tr_b16 v[234:235], v24 offset:34816
    v_cvt_pk_bf16_f32 v197, v138, v139
    s_nop 0
    v_add_f32 v3, v3, v140
    v_add_f32 v3, v3, v141
    v_add_f32 v3, v3, v142
    v_add_f32 v3, v3, v143
    v_cvt_pk_bf16_f32 v198, v140, v141
    s_waitcnt lgkmcnt(4)
    v_mfma_f32_32x32x16_bf16 v[176:191], v[212:215], v[52:55], v[176:191]
    ds_read_b64_tr_b16 v[236:237], v25 offset:32768
    ds_read_b64_tr_b16 v[238:239], v25 offset:34816
    v_cvt_pk_bf16_f32 v199, v142, v143
    s_waitcnt lgkmcnt(5)
    v_mfma_f32_32x32x16_bf16 v[176:191], v[216:219], v[56:59], v[176:191]
    ds_read_b64_tr_b16 v[240:241], v26 offset:32768
    ds_read_b64_tr_b16 v[242:243], v26 offset:34816
    s_waitcnt lgkmcnt(6)
    v_mfma_f32_32x32x16_bf16 v[176:191], v[220:223], v[60:63], v[176:191]
    ds_read_b64_tr_b16 v[244:245], v27 offset:32768
    ds_read_b64_tr_b16 v[246:247], v27 offset:34816
    s_waitcnt lgkmcnt(6)
    v_mfma_f32_32x32x16_bf16 v[64:79], v[232:235], v[192:195], v[64:79]
    ds_read_b64_tr_b16 v[248:249], v24 offset:36864
    ds_read_b64_tr_b16 v[250:251], v24 offset:38912
    v_fma_f32 v144, v144, s34, -v4
    v_fma_f32 v145, v145, s34, -v4
    v_fma_f32 v146, v146, s34, -v4
    v_fma_f32 v147, v147, s34, -v4
    v_exp_f32 v144, v144
    v_exp_f32 v145, v145
    v_exp_f32 v146, v146
    v_exp_f32 v147, v147
    v_fma_f32 v148, v148, s34, -v4
    s_waitcnt lgkmcnt(6)
    v_mfma_f32_32x32x16_bf16 v[80:95], v[236:239], v[192:195], v[80:95]
    ds_read_b64_tr_b16 v[252:253], v25 offset:36864
    ds_read_b64_tr_b16 v[254:255], v25 offset:38912
    v_fma_f32 v149, v149, s34, -v4
    v_fma_f32 v150, v150, s34, -v4
    v_fma_f32 v151, v151, s34, -v4
    v_exp_f32 v148, v148
    v_exp_f32 v149, v149
    v_exp_f32 v150, v150
    v_exp_f32 v151, v151
    v_add_f32 v3, v3, v144
    v_add_f32 v3, v3, v145
    s_waitcnt lgkmcnt(6)
    v_mfma_f32_32x32x16_bf16 v[96:111], v[240:243], v[192:195], v[96:111]
    ds_read_b64_tr_b16 v[232:233], v26 offset:36864
    ds_read_b64_tr_b16 v[234:235], v26 offset:38912
    v_add_f32 v3, v3, v146
    v_add_f32 v3, v3, v147
    v_cvt_pk_bf16_f32 v200, v144, v145
    v_cvt_pk_bf16_f32 v201, v146, v147
    v_fma_f32 v152, v152, s34, -v4
    v_fma_f32 v153, v153, s34, -v4
    v_fma_f32 v154, v154, s34, -v4
    v_fma_f32 v155, v155, s34, -v4
    v_exp_f32 v152, v152
    s_waitcnt lgkmcnt(6)
    v_mfma_f32_32x32x16_bf16 v[112:127], v[244:247], v[192:195], v[112:127]
    ds_read_b64_tr_b16 v[236:237], v27 offset:36864
    ds_read_b64_tr_b16 v[238:239], v27 offset:38912
    v_exp_f32 v153, v153
    v_exp_f32 v154, v154
    v_exp_f32 v155, v155
    v_add_f32 v3, v3, v148
    v_add_f32 v3, v3, v149
    v_add_f32 v3, v3, v150
    v_add_f32 v3, v3, v151
    v_cvt_pk_bf16_f32 v202, v148, v149
    v_cvt_pk_bf16_f32 v203, v150, v151
    s_waitcnt lgkmcnt(6)
    v_mfma_f32_32x32x16_bf16 v[64:79], v[248:251], v[196:199], v[64:79]
    ds_read_b64_tr_b16 v[240:241], v24 offset:40960
    ds_read_b64_tr_b16 v[242:243], v24 offset:43008
    v_fma_f32 v156, v156, s34, -v4
    v_fma_f32 v157, v157, s34, -v4
    v_fma_f32 v158, v158, s34, -v4
    v_fma_f32 v159, v159, s34, -v4
    v_exp_f32 v156, v156
    v_exp_f32 v157, v157
    v_exp_f32 v158, v158
    v_exp_f32 v159, v159
    v_add_f32 v3, v3, v152
    s_waitcnt lgkmcnt(6)
    v_mfma_f32_32x32x16_bf16 v[80:95], v[252:255], v[196:199], v[80:95]
    ds_read_b64_tr_b16 v[244:245], v25 offset:40960
    ds_read_b64_tr_b16 v[246:247], v25 offset:43008
    v_add_f32 v3, v3, v153
    v_add_f32 v3, v3, v154
    v_add_f32 v3, v3, v155
    v_cvt_pk_bf16_f32 v204, v152, v153
    v_cvt_pk_bf16_f32 v205, v154, v155
    s_nop 0
    v_add_f32 v3, v3, v156
    v_add_f32 v3, v3, v157
    v_add_f32 v3, v3, v158
    s_waitcnt lgkmcnt(6)
    v_mfma_f32_32x32x16_bf16 v[96:111], v[232:235], v[196:199], v[96:111]
    ds_read_b64_tr_b16 v[248:249], v26 offset:40960
    ds_read_b64_tr_b16 v[250:251], v26 offset:43008
    v_add_f32 v3, v3, v159
    v_cvt_pk_bf16_f32 v206, v156, v157
    v_cvt_pk_bf16_f32 v207, v158, v159
    s_waitcnt lgkmcnt(6)
    v_mfma_f32_32x32x16_bf16 v[112:127], v[236:239], v[196:199], v[112:127]
    ds_read_b64_tr_b16 v[252:253], v27 offset:40960
    ds_read_b64_tr_b16 v[254:255], v27 offset:43008
    s_nop 1
    s_waitcnt lgkmcnt(6)
    v_mfma_f32_32x32x16_bf16 v[64:79], v[240:243], v[200:203], v[64:79]
    ds_read_b64_tr_b16 v[232:233], v24 offset:45056
    ds_read_b64_tr_b16 v[234:235], v24 offset:47104
    s_waitcnt lgkmcnt(6)
    v_mfma_f32_32x32x16_bf16 v[80:95], v[244:247], v[200:203], v[80:95]
    ds_read_b64_tr_b16 v[236:237], v25 offset:45056
    ds_read_b64_tr_b16 v[238:239], v25 offset:47104
    s_waitcnt lgkmcnt(6)
    v_mfma_f32_32x32x16_bf16 v[96:111], v[248:251], v[200:203], v[96:111]
    ds_read_b64_tr_b16 v[240:241], v26 offset:45056
    ds_read_b64_tr_b16 v[242:243], v26 offset:47104
    s_waitcnt lgkmcnt(6)
    v_mfma_f32_32x32x16_bf16 v[112:127], v[252:255], v[200:203], v[112:127]
    ds_read_b64_tr_b16 v[244:245], v27 offset:45056
    ds_read_b64_tr_b16 v[246:247], v27 offset:47104
    s_waitcnt lgkmcnt(6)
    v_mfma_f32_32x32x16_bf16 v[64:79], v[232:235], v[204:207], v[64:79]
    s_waitcnt lgkmcnt(4)
    v_mfma_f32_32x32x16_bf16 v[80:95], v[236:239], v[204:207], v[80:95]
    s_waitcnt lgkmcnt(2)
    v_mfma_f32_32x32x16_bf16 v[96:111], v[240:243], v[204:207], v[96:111]
    s_waitcnt lgkmcnt(0)
    v_mfma_f32_32x32x16_bf16 v[112:127], v[244:247], v[204:207], v[112:127]
    s_waitcnt vmcnt(0)
    s_barrier
    ds_read_b64_tr_b16 v[232:233], v24 offset:49152
    ds_read_b64_tr_b16 v[234:235], v24 offset:51200
    ds_read_b64_tr_b16 v[236:237], v25 offset:49152
    ds_read_b64_tr_b16 v[238:239], v25 offset:51200
    ds_read_b64_tr_b16 v[240:241], v26 offset:49152
    ds_read_b64_tr_b16 v[242:243], v26 offset:51200
    ds_read_b64_tr_b16 v[244:245], v27 offset:49152
    ds_read_b64_tr_b16 v[246:247], v27 offset:51200
    v_max3_f32 v1, v160, v161, v162
    v_max3_f32 v6, v176, v177, v178
    v_max3_f32 v1, v1, v163, v164
    v_max3_f32 v6, v6, v179, v180
    v_max3_f32 v1, v1, v165, v166
    v_max3_f32 v6, v6, v181, v182
    v_max3_f32 v1, v1, v167, v168
    v_max3_f32 v6, v6, v183, v184
    v_max3_f32 v1, v1, v169, v170
    v_max3_f32 v6, v6, v185, v186
    v_max3_f32 v1, v1, v171, v172
    v_max3_f32 v6, v6, v187, v188
    v_max3_f32 v1, v1, v173, v174
    v_max3_f32 v6, v6, v189, v190
    v_max3_f32 v1, v1, v175, v191
    v_max_f32 v1, v1, v6
    v_mov_b32 v6, v1
    s_nop 1
    v_permlane32_swap_b32 v1, v6
    v_max_f32 v1, v1, v6
    v_fma_f32 v6, v1, s34, -v4
    v_cmp_lt_f32 vcc, s35, v6
    s_nop 4
    s_cbranch_vccnz L_rare15
L_back15:
    v_fma_f32 v160, v160, s34, -v4
    v_fma_f32 v161, v161, s34, -v4
    v_fma_f32 v162, v162, s34, -v4
    v_fma_f32 v163, v163, s34, -v4
    v_exp_f32 v160, v160
    v_exp_f32 v161, v161
    v_exp_f32 v162, v162
    v_exp_f32 v163, v163
    v_fma_f32 v164, v164, s34, -v4
    v_fma_f32 v165, v165, s34, -v4
    v_fma_f32 v166, v166, s34, -v4
    v_fma_f32 v167, v167, s34, -v4
    v_exp_f32 v164, v164
    v_exp_f32 v165, v165
    v_exp_f32 v166, v166
    v_exp_f32 v167, v167
    v_add_f32 v3, v3, v160
    v_add_f32 v3, v3, v161
    v_add_f32 v3, v3, v162
    v_add_f32 v3, v3, v163
    v_cvt_pk_bf16_f32 v192, v160, v161
    v_cvt_pk_bf16_f32 v193, v162, v163
    v_fma_f32 v168, v168, s34, -v4
    v_fma_f32 v169, v169, s34, -v4
    v_fma_f32 v170, v170, s34, -v4
    v_fma_f32 v171, v171, s34, -v4
    v_exp_f32 v168, v168
    v_exp_f32 v169, v169
    v_exp_f32 v170, v170
    v_exp_f32 v171, v171
    v_add_f32 v3, v3, v164
    v_add_f32 v3, v3, v165
    v_add_f32 v3, v3, v166
    v_add_f32 v3, v3, v167
    v_cvt_pk_bf16_f32 v194, v164, v165
    v_cvt_pk_bf16_f32 v195, v166, v167
    v_fma_f32 v172, v172, s34, -v4
    v_fma_f32 v173, v173, s34, -v4
    v_fma_f32 v174, v174, s34, -v4
    v_fma_f32 v175, v175, s34, -v4
    v_exp_f32 v172, v172
    v_exp_f32 v173, v173
    v_exp_f32 v174, v174
    v_exp_f32 v175, v175
    v_add_f32 v3, v3, v168
    v_add_f32 v3, v3, v169
    v_add_f32 v3, v3, v170
    v_add_f32 v3, v3, v171
    v_cvt_pk_bf16_f32 v196, v168, v169
    v_cvt_pk_bf16_f32 v197, v170, v171
    s_nop 0
    v_add_f32 v3, v3, v172
    v_add_f32 v3, v3, v173
    v_add_f32 v3, v3, v174
    v_add_f32 v3, v3, v175
    v_cvt_pk_bf16_f32 v198, v172, v173
    v_cvt_pk_bf16_f32 v199, v174, v175
    s_nop 1
    s_waitcnt lgkmcnt(6)
    v_mfma_f32_32x32x16_bf16 v[64:79], v[232:235], v[192:195], v[64:79]
    ds_read_b64_tr_b16 v[248:249], v24 offset:53248
    ds_read_b64_tr_b16 v[250:251], v24 offset:55296
    v_fma_f32 v176, v176, s34, -v4
    v_fma_f32 v177, v177, s34, -v4
    v_fma_f32 v178, v178, s34, -v4
    v_fma_f32 v179, v179, s34, -v4
    v_exp_f32 v176, v176
    v_exp_f32 v177, v177
    v_exp_f32 v178, v178
    v_exp_f32 v179, v179
    v_fma_f32 v180, v180, s34, -v4
    s_waitcnt lgkmcnt(6)
    v_mfma_f32_32x32x16_bf16 v[80:95], v[236:239], v[192:195], v[80:95]
    ds_read_b64_tr_b16 v[252:253], v25 offset:53248
    ds_read_b64_tr_b16 v[254:255], v25 offset:55296
    v_fma_f32 v181, v181, s34, -v4
    v_fma_f32 v182, v182, s34, -v4
    v_fma_f32 v183, v183, s34, -v4
    v_exp_f32 v180, v180
    v_exp_f32 v181, v181
    v_exp_f32 v182, v182
    v_exp_f32 v183, v183
    v_add_f32 v3, v3, v176
    v_add_f32 v3, v3, v177
    s_waitcnt lgkmcnt(6)
    v_mfma_f32_32x32x16_bf16 v[96:111], v[240:243], v[192:195], v[96:111]
    ds_read_b64_tr_b16 v[232:233], v26 offset:53248
    ds_read_b64_tr_b16 v[234:235], v26 offset:55296
    v_add_f32 v3, v3, v178
    v_add_f32 v3, v3, v179
    v_cvt_pk_bf16_f32 v200, v176, v177
    v_cvt_pk_bf16_f32 v201, v178, v179
    v_fma_f32 v184, v184, s34, -v4
    v_fma_f32 v185, v185, s34, -v4
    v_fma_f32 v186, v186, s34, -v4
    v_fma_f32 v187, v187, s34, -v4
    v_exp_f32 v184, v184
    s_waitcnt lgkmcnt(6)
    v_mfma_f32_32x32x16_bf16 v[112:127], v[244:247], v[192:195], v[112:127]
    ds_read_b64_tr_b16 v[236:237], v27 offset:53248
    ds_read_b64_tr_b16 v[238:239], v27 offset:55296
    v_exp_f32 v185, v185
    v_exp_f32 v186, v186
    v_exp_f32 v187, v187
    v_add_f32 v3, v3, v180
    v_add_f32 v3, v3, v181
    v_add_f32 v3, v3, v182
    v_add_f32 v3, v3, v183
    v_cvt_pk_bf16_f32 v202, v180, v181
    v_cvt_pk_bf16_f32 v203, v182, v183
    s_waitcnt lgkmcnt(6)
    v_mfma_f32_32x32x16_bf16 v[64:79], v[248:251], v[196:199], v[64:79]
    ds_read_b64_tr_b16 v[240:241], v24 offset:57344
    ds_read_b64_tr_b16 v[242:243], v24 offset:59392
    v_fma_f32 v188, v188, s34, -v4
    v_fma_f32 v189, v189, s34, -v4
    v_fma_f32 v190, v190, s34, -v4
    v_fma_f32 v191, v191, s34, -v4
    v_exp_f32 v188, v188
    v_exp_f32 v189, v189
    v_exp_f32 v190, v190
    v_exp_f32 v191, v191
    v_add_f32 v3, v3, v184
    s_waitcnt lgkmcnt(6)
    v_mfma_f32_32x32x16_bf16 v[80:95], v[252:255], v[196:199], v[80:95]
    ds_read_b64_tr_b16 v[244:245], v25 offset:57344
    ds_read_b64_tr_b16 v[246:247], v25 offset:59392
    v_add_f32 v3, v3, v185
    v_add_f32 v3, v3, v186
    v_add_f32 v3, v3, v187
    v_cvt_pk_bf16_f32 v204, v184, v185
    v_cvt_pk_bf16_f32 v205, v186, v187
    s_nop 0
    v_add_f32 v3, v3, v188
    v_add_f32 v3, v3, v189
    v_add_f32 v3, v3, v190
    s_waitcnt lgkmcnt(6)
    v_mfma_f32_32x32x16_bf16 v[96:111], v[232:235], v[196:199], v[96:111]
    ds_read_b64_tr_b16 v[248:249], v26 offset:57344
    ds_read_b64_tr_b16 v[250:251], v26 offset:59392
    v_add_f32 v3, v3, v191
    v_cvt_pk_bf16_f32 v206, v188, v189
    v_cvt_pk_bf16_f32 v207, v190, v191
    s_waitcnt lgkmcnt(6)
    v_mfma_f32_32x32x16_bf16 v[112:127], v[236:239], v[196:199], v[112:127]
    ds_read_b64_tr_b16 v[252:253], v27 offset:57344
    ds_read_b64_tr_b16 v[254:255], v27 offset:59392
    s_nop 1
    s_waitcnt lgkmcnt(6)
    v_mfma_f32_32x32x16_bf16 v[64:79], v[240:243], v[200:203], v[64:79]
    ds_read_b64_tr_b16 v[232:233], v24 offset:61440
    ds_read_b64_tr_b16 v[234:235], v24 offset:63488
    s_waitcnt lgkmcnt(6)
    v_mfma_f32_32x32x16_bf16 v[80:95], v[244:247], v[200:203], v[80:95]
    ds_read_b64_tr_b16 v[236:237], v25 offset:61440
    ds_read_b64_tr_b16 v[238:239], v25 offset:63488
    s_waitcnt lgkmcnt(6)
    v_mfma_f32_32x32x16_bf16 v[96:111], v[248:251], v[200:203], v[96:111]
    ds_read_b64_tr_b16 v[240:241], v26 offset:61440
    ds_read_b64_tr_b16 v[242:243], v26 offset:63488
    s_waitcnt lgkmcnt(6)
    v_mfma_f32_32x32x16_bf16 v[112:127], v[252:255], v[200:203], v[112:127]
    ds_read_b64_tr_b16 v[244:245], v27 offset:61440
    ds_read_b64_tr_b16 v[246:247], v27 offset:63488
    s_waitcnt lgkmcnt(6)
    v_mfma_f32_32x32x16_bf16 v[64:79], v[232:235], v[204:207], v[64:79]
    s_waitcnt lgkmcnt(4)
    v_mfma_f32_32x32x16_bf16 v[80:95], v[236:239], v[204:207], v[80:95]
    s_waitcnt lgkmcnt(2)
    v_mfma_f32_32x32x16_bf16 v[96:111], v[240:243], v[204:207], v[96:111]
    s_waitcnt lgkmcnt(0)
    v_mfma_f32_32x32x16_bf16 v[112:127], v[244:247], v[204:207], v[112:127]
    v_add_f32 v14, v14, v15
    v_add_f32 v3, v3, v14
    v_mov_b32 v6, v3
    s_nop 1
    v_permlane32_swap_b32 v3, v6
    v_add_f32 v3, v3, v6
    v_rcp_f32 v3, v3
    s_nop 7
    s_nop 3
    v_mul_f32 v64, v64, v3
    v_mul_f32 v65, v65, v3
    v_mul_f32 v66, v66, v3
    v_mul_f32 v67, v67, v3
    v_mul_f32 v68, v68, v3
    v_mul_f32 v69, v69, v3
    v_mul_f32 v70, v70, v3
    v_mul_f32 v71, v71, v3
    v_cvt_pk_bf16_f32 v128, v64, v65
    v_cvt_pk_bf16_f32 v129, v66, v67
    v_cvt_pk_bf16_f32 v130, v68, v69
    v_cvt_pk_bf16_f32 v131, v70, v71
    s_nop 1
    v_permlane32_swap_b32 v128, v130
    v_permlane32_swap_b32 v129, v131
    buffer_store_dwordx4 v[128:131], v13, s[24:27], 0 offen offset:0
    v_mul_f32 v72, v72, v3
    v_mul_f32 v73, v73, v3
    v_mul_f32 v74, v74, v3
    v_mul_f32 v75, v75, v3
    v_mul_f32 v76, v76, v3
    v_mul_f32 v77, v77, v3
    v_mul_f32 v78, v78, v3
    v_mul_f32 v79, v79, v3
    v_cvt_pk_bf16_f32 v132, v72, v73
    v_cvt_pk_bf16_f32 v133, v74, v75
    v_cvt_pk_bf16_f32 v134, v76, v77
    v_cvt_pk_bf16_f32 v135, v78, v79
    s_nop 1
    v_permlane32_swap_b32 v132, v134
    v_permlane32_swap_b32 v133, v135
    buffer_store_dwordx4 v[132:135], v13, s[24:27], 0 offen offset:32
    v_mul_f32 v80, v80, v3
    v_mul_f32 v81, v81, v3
    v_mul_f32 v82, v82, v3
    v_mul_f32 v83, v83, v3
    v_mul_f32 v84, v84, v3
    v_mul_f32 v85, v85, v3
    v_mul_f32 v86, v86, v3
    v_mul_f32 v87, v87, v3
    v_cvt_pk_bf16_f32 v136, v80, v81
    v_cvt_pk_bf16_f32 v137, v82, v83
    v_cvt_pk_bf16_f32 v138, v84, v85
    v_cvt_pk_bf16_f32 v139, v86, v87
    s_nop 1
    v_permlane32_swap_b32 v136, v138
    v_permlane32_swap_b32 v137, v139
    buffer_store_dwordx4 v[136:139], v13, s[24:27], 0 offen offset:64
    v_mul_f32 v88, v88, v3
    v_mul_f32 v89, v89, v3
    v_mul_f32 v90, v90, v3
    v_mul_f32 v91, v91, v3
    v_mul_f32 v92, v92, v3
    v_mul_f32 v93, v93, v3
    v_mul_f32 v94, v94, v3
    v_mul_f32 v95, v95, v3
    v_cvt_pk_bf16_f32 v140, v88, v89
    v_cvt_pk_bf16_f32 v141, v90, v91
    v_cvt_pk_bf16_f32 v142, v92, v93
    v_cvt_pk_bf16_f32 v143, v94, v95
    s_nop 1
    v_permlane32_swap_b32 v140, v142
    v_permlane32_swap_b32 v141, v143
    buffer_store_dwordx4 v[140:143], v13, s[24:27], 0 offen offset:96
    v_mul_f32 v96, v96, v3
    v_mul_f32 v97, v97, v3
    v_mul_f32 v98, v98, v3
    v_mul_f32 v99, v99, v3
    v_mul_f32 v100, v100, v3
    v_mul_f32 v101, v101, v3
    v_mul_f32 v102, v102, v3
    v_mul_f32 v103, v103, v3
    v_cvt_pk_bf16_f32 v144, v96, v97
    v_cvt_pk_bf16_f32 v145, v98, v99
    v_cvt_pk_bf16_f32 v146, v100, v101
    v_cvt_pk_bf16_f32 v147, v102, v103
    s_nop 1
    v_permlane32_swap_b32 v144, v146
    v_permlane32_swap_b32 v145, v147
    buffer_store_dwordx4 v[144:147], v13, s[24:27], 0 offen offset:128
    v_mul_f32 v104, v104, v3
    v_mul_f32 v105, v105, v3
    v_mul_f32 v106, v106, v3
    v_mul_f32 v107, v107, v3
    v_mul_f32 v108, v108, v3
    v_mul_f32 v109, v109, v3
    v_mul_f32 v110, v110, v3
    v_mul_f32 v111, v111, v3
    v_cvt_pk_bf16_f32 v148, v104, v105
    v_cvt_pk_bf16_f32 v149, v106, v107
    v_cvt_pk_bf16_f32 v150, v108, v109
    v_cvt_pk_bf16_f32 v151, v110, v111
    s_nop 1
    v_permlane32_swap_b32 v148, v150
    v_permlane32_swap_b32 v149, v151
    buffer_store_dwordx4 v[148:151], v13, s[24:27], 0 offen offset:160
    v_mul_f32 v112, v112, v3
    v_mul_f32 v113, v113, v3
    v_mul_f32 v114, v114, v3
    v_mul_f32 v115, v115, v3
    v_mul_f32 v116, v116, v3
    v_mul_f32 v117, v117, v3
    v_mul_f32 v118, v118, v3
    v_mul_f32 v119, v119, v3
    v_cvt_pk_bf16_f32 v152, v112, v113
    v_cvt_pk_bf16_f32 v153, v114, v115
    v_cvt_pk_bf16_f32 v154, v116, v117
    v_cvt_pk_bf16_f32 v155, v118, v119
    s_nop 1
    v_permlane32_swap_b32 v152, v154
    v_permlane32_swap_b32 v153, v155
    buffer_store_dwordx4 v[152:155], v13, s[24:27], 0 offen offset:192
    v_mul_f32 v120, v120, v3
    v_mul_f32 v121, v121, v3
    v_mul_f32 v122, v122, v3
    v_mul_f32 v123, v123, v3
    v_mul_f32 v124, v124, v3
    v_mul_f32 v125, v125, v3
    v_mul_f32 v126, v126, v3
    v_mul_f32 v127, v127, v3
    v_cvt_pk_bf16_f32 v156, v120, v121
    v_cvt_pk_bf16_f32 v157, v122, v123
    v_cvt_pk_bf16_f32 v158, v124, v125
    v_cvt_pk_bf16_f32 v159, v126, v127
    s_nop 1
    v_permlane32_swap_b32 v156, v158
    v_permlane32_swap_b32 v157, v159
    buffer_store_dwordx4 v[156:159], v13, s[24:27], 0 offen offset:224
L_end:
    s_endpgm
L_rare0:
    s_nop 7
    s_nop 7
    v_max_f32 v2, v2, v1
    v_mul_f32 v7, s34, v2
    v_sub_f32 v5, v4, v7
    v_exp_f32 v5, v5
    v_mov_b32 v4, v7
    s_nop 0
    v_mul_f32 v3, v3, v5
    v_mul_f32 v14, v14, v5
    v_mul_f32 v15, v15, v5
    v_sub_f32 v8, 0, v4
    v_sub_f32 v9, 0, v4
    v_mul_f32 v64, v64, v5
    v_mul_f32 v65, v65, v5
    v_mul_f32 v66, v66, v5
    v_mul_f32 v67, v67, v5
    v_mul_f32 v68, v68, v5
    v_mul_f32 v69, v69, v5
    v_mul_f32 v70, v70, v5
    v_mul_f32 v71, v71, v5
    v_mul_f32 v72, v72, v5
    v_mul_f32 v73, v73, v5
    v_mul_f32 v74, v74, v5
    v_mul_f32 v75, v75, v5
    v_mul_f32 v76, v76, v5
    v_mul_f32 v77, v77, v5
    v_mul_f32 v78, v78, v5
    v_mul_f32 v79, v79, v5
    v_mul_f32 v80, v80, v5
    v_mul_f32 v81, v81, v5
    v_mul_f32 v82, v82, v5
    v_mul_f32 v83, v83, v5
    v_mul_f32 v84, v84, v5
    v_mul_f32 v85, v85, v5
    v_mul_f32 v86, v86, v5
    v_mul_f32 v87, v87, v5
    v_mul_f32 v88, v88, v5
    v_mul_f32 v89, v89, v5
    v_mul_f32 v90, v90, v5
    v_mul_f32 v91, v91, v5
    v_mul_f32 v92, v92, v5
    v_mul_f32 v93, v93, v5
    v_mul_f32 v94, v94, v5
    v_mul_f32 v95, v95, v5
    v_mul_f32 v96, v96, v5
    v_mul_f32 v97, v97, v5
    v_mul_f32 v98, v98, v5
    v_mul_f32 v99, v99, v5
    v_mul_f32 v100, v100, v5
    v_mul_f32 v101, v101, v5
    v_mul_f32 v102, v102, v5
    v_mul_f32 v103, v103, v5
    v_mul_f32 v104, v104, v5
    v_mul_f32 v105, v105, v5
    v_mul_f32 v106, v106, v5
    v_mul_f32 v107, v107, v5
    v_mul_f32 v108, v108, v5
    v_mul_f32 v109, v109, v5
    v_mul_f32 v110, v110, v5
    v_mul_f32 v111, v111, v5
    v_mul_f32 v112, v112, v5
    v_mul_f32 v113, v113, v5
    v_mul_f32 v114, v114, v5
    v_mul_f32 v115, v115, v5
    v_mul_f32 v116, v116, v5
    v_mul_f32 v117, v117, v5
    v_mul_f32 v118, v118, v5
    v_mul_f32 v119, v119, v5
    v_mul_f32 v120, v120, v5
    v_mul_f32 v121, v121, v5
    v_mul_f32 v122, v122, v5
    v_mul_f32 v123, v123, v5
    v_mul_f32 v124, v124, v5
    v_mul_f32 v125, v125, v5
    v_mul_f32 v126, v126, v5
    v_mul_f32 v127, v127, v5
    s_branch L_back0
L_rare1:
    s_nop 7
    s_nop 7
    v_max_f32 v2, v2, v1
    v_mul_f32 v7, s34, v2
    v_sub_f32 v5, v4, v7
    v_exp_f32 v5, v5
    v_mov_b32 v4, v7
    s_nop 0
    v_mul_f32 v3, v3, v5
    v_mul_f32 v14, v14, v5
    v_mul_f32 v15, v15, v5
    v_sub_f32 v8, 0, v4
    v_sub_f32 v9, 0, v4
    v_mul_f32 v64, v64, v5
    v_mul_f32 v65, v65, v5
    v_mul_f32 v66, v66, v5
    v_mul_f32 v67, v67, v5
    v_mul_f32 v68, v68, v5
    v_mul_f32 v69, v69, v5
    v_mul_f32 v70, v70, v5
    v_mul_f32 v71, v71, v5
    v_mul_f32 v72, v72, v5
    v_mul_f32 v73, v73, v5
    v_mul_f32 v74, v74, v5
    v_mul_f32 v75, v75, v5
    v_mul_f32 v76, v76, v5
    v_mul_f32 v77, v77, v5
    v_mul_f32 v78, v78, v5
    v_mul_f32 v79, v79, v5
    v_mul_f32 v80, v80, v5
    v_mul_f32 v81, v81, v5
    v_mul_f32 v82, v82, v5
    v_mul_f32 v83, v83, v5
    v_mul_f32 v84, v84, v5
    v_mul_f32 v85, v85, v5
    v_mul_f32 v86, v86, v5
    v_mul_f32 v87, v87, v5
    v_mul_f32 v88, v88, v5
    v_mul_f32 v89, v89, v5
    v_mul_f32 v90, v90, v5
    v_mul_f32 v91, v91, v5
    v_mul_f32 v92, v92, v5
    v_mul_f32 v93, v93, v5
    v_mul_f32 v94, v94, v5
    v_mul_f32 v95, v95, v5
    v_mul_f32 v96, v96, v5
    v_mul_f32 v97, v97, v5
    v_mul_f32 v98, v98, v5
    v_mul_f32 v99, v99, v5
    v_mul_f32 v100, v100, v5
    v_mul_f32 v101, v101, v5
    v_mul_f32 v102, v102, v5
    v_mul_f32 v103, v103, v5
    v_mul_f32 v104, v104, v5
    v_mul_f32 v105, v105, v5
    v_mul_f32 v106, v106, v5
    v_mul_f32 v107, v107, v5
    v_mul_f32 v108, v108, v5
    v_mul_f32 v109, v109, v5
    v_mul_f32 v110, v110, v5
    v_mul_f32 v111, v111, v5
    v_mul_f32 v112, v112, v5
    v_mul_f32 v113, v113, v5
    v_mul_f32 v114, v114, v5
    v_mul_f32 v115, v115, v5
    v_mul_f32 v116, v116, v5
    v_mul_f32 v117, v117, v5
    v_mul_f32 v118, v118, v5
    v_mul_f32 v119, v119, v5
    v_mul_f32 v120, v120, v5
    v_mul_f32 v121, v121, v5
    v_mul_f32 v122, v122, v5
    v_mul_f32 v123, v123, v5
    v_mul_f32 v124, v124, v5
    v_mul_f32 v125, v125, v5
    v_mul_f32 v126, v126, v5
    v_mul_f32 v127, v127, v5
    s_branch L_back1
L_rare2:
    s_nop 7
    s_nop 7
    v_max_f32 v2, v2, v1
    v_mul_f32 v7, s34, v2
    v_sub_f32 v5, v4, v7
    v_exp_f32 v5, v5
    v_mov_b32 v4, v7
    s_nop 0
    v_mul_f32 v3, v3, v5
    v_mul_f32 v14, v14, v5
    v_mul_f32 v15, v15, v5
    v_sub_f32 v8, 0, v4
    v_sub_f32 v9, 0, v4
    v_mul_f32 v64, v64, v5
    v_mul_f32 v65, v65, v5
    v_mul_f32 v66, v66, v5
    v_mul_f32 v67, v67, v5
    v_mul_f32 v68, v68, v5
    v_mul_f32 v69, v69, v5
    v_mul_f32 v70, v70, v5
    v_mul_f32 v71, v71, v5
    v_mul_f32 v72, v72, v5
    v_mul_f32 v73, v73, v5
    v_mul_f32 v74, v74, v5
    v_mul_f32 v75, v75, v5
    v_mul_f32 v76, v76, v5
    v_mul_f32 v77, v77, v5
    v_mul_f32 v78, v78, v5
    v_mul_f32 v79, v79, v5
    v_mul_f32 v80, v80, v5
    v_mul_f32 v81, v81, v5
    v_mul_f32 v82, v82, v5
    v_mul_f32 v83, v83, v5
    v_mul_f32 v84, v84, v5
    v_mul_f32 v85, v85, v5
    v_mul_f32 v86, v86, v5
    v_mul_f32 v87, v87, v5
    v_mul_f32 v88, v88, v5
    v_mul_f32 v89, v89, v5
    v_mul_f32 v90, v90, v5
    v_mul_f32 v91, v91, v5
    v_mul_f32 v92, v92, v5
    v_mul_f32 v93, v93, v5
    v_mul_f32 v94, v94, v5
    v_mul_f32 v95, v95, v5
    v_mul_f32 v96, v96, v5
    v_mul_f32 v97, v97, v5
    v_mul_f32 v98, v98, v5
    v_mul_f32 v99, v99, v5
    v_mul_f32 v100, v100, v5
    v_mul_f32 v101, v101, v5
    v_mul_f32 v102, v102, v5
    v_mul_f32 v103, v103, v5
    v_mul_f32 v104, v104, v5
    v_mul_f32 v105, v105, v5
    v_mul_f32 v106, v106, v5
    v_mul_f32 v107, v107, v5
    v_mul_f32 v108, v108, v5
    v_mul_f32 v109, v109, v5
    v_mul_f32 v110, v110, v5
    v_mul_f32 v111, v111, v5
    v_mul_f32 v112, v112, v5
    v_mul_f32 v113, v113, v5
    v_mul_f32 v114, v114, v5
    v_mul_f32 v115, v115, v5
    v_mul_f32 v116, v116, v5
    v_mul_f32 v117, v117, v5
    v_mul_f32 v118, v118, v5
    v_mul_f32 v119, v119, v5
    v_mul_f32 v120, v120, v5
    v_mul_f32 v121, v121, v5
    v_mul_f32 v122, v122, v5
    v_mul_f32 v123, v123, v5
    v_mul_f32 v124, v124, v5
    v_mul_f32 v125, v125, v5
    v_mul_f32 v126, v126, v5
    v_mul_f32 v127, v127, v5
    s_branch L_back2
L_rare3:
    s_nop 7
    s_nop 7
    v_max_f32 v2, v2, v1
    v_mul_f32 v7, s34, v2
    v_sub_f32 v5, v4, v7
    v_exp_f32 v5, v5
    v_mov_b32 v4, v7
    s_nop 0
    v_mul_f32 v3, v3, v5
    v_mul_f32 v14, v14, v5
    v_mul_f32 v15, v15, v5
    v_sub_f32 v8, 0, v4
    v_sub_f32 v9, 0, v4
    v_mul_f32 v64, v64, v5
    v_mul_f32 v65, v65, v5
    v_mul_f32 v66, v66, v5
    v_mul_f32 v67, v67, v5
    v_mul_f32 v68, v68, v5
    v_mul_f32 v69, v69, v5
    v_mul_f32 v70, v70, v5
    v_mul_f32 v71, v71, v5
    v_mul_f32 v72, v72, v5
    v_mul_f32 v73, v73, v5
    v_mul_f32 v74, v74, v5
    v_mul_f32 v75, v75, v5
    v_mul_f32 v76, v76, v5
    v_mul_f32 v77, v77, v5
    v_mul_f32 v78, v78, v5
    v_mul_f32 v79, v79, v5
    v_mul_f32 v80, v80, v5
    v_mul_f32 v81, v81, v5
    v_mul_f32 v82, v82, v5
    v_mul_f32 v83, v83, v5
    v_mul_f32 v84, v84, v5
    v_mul_f32 v85, v85, v5
    v_mul_f32 v86, v86, v5
    v_mul_f32 v87, v87, v5
    v_mul_f32 v88, v88, v5
    v_mul_f32 v89, v89, v5
    v_mul_f32 v90, v90, v5
    v_mul_f32 v91, v91, v5
    v_mul_f32 v92, v92, v5
    v_mul_f32 v93, v93, v5
    v_mul_f32 v94, v94, v5
    v_mul_f32 v95, v95, v5
    v_mul_f32 v96, v96, v5
    v_mul_f32 v97, v97, v5
    v_mul_f32 v98, v98, v5
    v_mul_f32 v99, v99, v5
    v_mul_f32 v100, v100, v5
    v_mul_f32 v101, v101, v5
    v_mul_f32 v102, v102, v5
    v_mul_f32 v103, v103, v5
    v_mul_f32 v104, v104, v5
    v_mul_f32 v105, v105, v5
    v_mul_f32 v106, v106, v5
    v_mul_f32 v107, v107, v5
    v_mul_f32 v108, v108, v5
    v_mul_f32 v109, v109, v5
    v_mul_f32 v110, v110, v5
    v_mul_f32 v111, v111, v5
    v_mul_f32 v112, v112, v5
    v_mul_f32 v113, v113, v5
    v_mul_f32 v114, v114, v5
    v_mul_f32 v115, v115, v5
    v_mul_f32 v116, v116, v5
    v_mul_f32 v117, v117, v5
    v_mul_f32 v118, v118, v5
    v_mul_f32 v119, v119, v5
    v_mul_f32 v120, v120, v5
    v_mul_f32 v121, v121, v5
    v_mul_f32 v122, v122, v5
    v_mul_f32 v123, v123, v5
    v_mul_f32 v124, v124, v5
    v_mul_f32 v125, v125, v5
    v_mul_f32 v126, v126, v5
    v_mul_f32 v127, v127, v5
    s_branch L_back3
L_rare12:
    s_nop 7
    s_nop 7
    v_max_f32 v2, v2, v1
    v_mul_f32 v7, s34, v2
    v_sub_f32 v5, v4, v7
    v_exp_f32 v5, v5
    v_mov_b32 v4, v7
    s_nop 0
    v_mul_f32 v3, v3, v5
    v_mul_f32 v14, v14, v5
    v_mul_f32 v15, v15, v5
    v_sub_f32 v8, 0, v4
    v_sub_f32 v9, 0, v4
    v_mul_f32 v64, v64, v5
    v_mul_f32 v65, v65, v5
    v_mul_f32 v66, v66, v5
    v_mul_f32 v67, v67, v5
    v_mul_f32 v68, v68, v5
    v_mul_f32 v69, v69, v5
    v_mul_f32 v70, v70, v5
    v_mul_f32 v71, v71, v5
    v_mul_f32 v72, v72, v5
    v_mul_f32 v73, v73, v5
    v_mul_f32 v74, v74, v5
    v_mul_f32 v75, v75, v5
    v_mul_f32 v76, v76, v5
    v_mul_f32 v77, v77, v5
    v_mul_f32 v78, v78, v5
    v_mul_f32 v79, v79, v5
    v_mul_f32 v80, v80, v5
    v_mul_f32 v81, v81, v5
    v_mul_f32 v82, v82, v5
    v_mul_f32 v83, v83, v5
    v_mul_f32 v84, v84, v5
    v_mul_f32 v85, v85, v5
    v_mul_f32 v86, v86, v5
    v_mul_f32 v87, v87, v5
    v_mul_f32 v88, v88, v5
    v_mul_f32 v89, v89, v5
    v_mul_f32 v90, v90, v5
    v_mul_f32 v91, v91, v5
    v_mul_f32 v92, v92, v5
    v_mul_f32 v93, v93, v5
    v_mul_f32 v94, v94, v5
    v_mul_f32 v95, v95, v5
    v_mul_f32 v96, v96, v5
    v_mul_f32 v97, v97, v5
    v_mul_f32 v98, v98, v5
    v_mul_f32 v99, v99, v5
    v_mul_f32 v100, v100, v5
    v_mul_f32 v101, v101, v5
    v_mul_f32 v102, v102, v5
    v_mul_f32 v103, v103, v5
    v_mul_f32 v104, v104, v5
    v_mul_f32 v105, v105, v5
    v_mul_f32 v106, v106, v5
    v_mul_f32 v107, v107, v5
    v_mul_f32 v108, v108, v5
    v_mul_f32 v109, v109, v5
    v_mul_f32 v110, v110, v5
    v_mul_f32 v111, v111, v5
    v_mul_f32 v112, v112, v5
    v_mul_f32 v113, v113, v5
    v_mul_f32 v114, v114, v5
    v_mul_f32 v115, v115, v5
    v_mul_f32 v116, v116, v5
    v_mul_f32 v117, v117, v5
    v_mul_f32 v118, v118, v5
    v_mul_f32 v119, v119, v5
    v_mul_f32 v120, v120, v5
    v_mul_f32 v121, v121, v5
    v_mul_f32 v122, v122, v5
    v_mul_f32 v123, v123, v5
    v_mul_f32 v124, v124, v5
    v_mul_f32 v125, v125, v5
    v_mul_f32 v126, v126, v5
    v_mul_f32 v127, v127, v5
    s_branch L_back12
L_rare13:
    s_nop 7
    s_nop 7
    v_max_f32 v2, v2, v1
    v_mul_f32 v7, s34, v2
    v_sub_f32 v5, v4, v7
    v_exp_f32 v5, v5
    v_mov_b32 v4, v7
    s_nop 0
    v_mul_f32 v3, v3, v5
    v_mul_f32 v14, v14, v5
    v_mul_f32 v15, v15, v5
    v_sub_f32 v8, 0, v4
    v_sub_f32 v9, 0, v4
    v_mul_f32 v64, v64, v5
    v_mul_f32 v65, v65, v5
    v_mul_f32 v66, v66, v5
    v_mul_f32 v67, v67, v5
    v_mul_f32 v68, v68, v5
    v_mul_f32 v69, v69, v5
    v_mul_f32 v70, v70, v5
    v_mul_f32 v71, v71, v5
    v_mul_f32 v72, v72, v5
    v_mul_f32 v73, v73, v5
    v_mul_f32 v74, v74, v5
    v_mul_f32 v75, v75, v5
    v_mul_f32 v76, v76, v5
    v_mul_f32 v77, v77, v5
    v_mul_f32 v78, v78, v5
    v_mul_f32 v79, v79, v5
    v_mul_f32 v80, v80, v5
    v_mul_f32 v81, v81, v5
    v_mul_f32 v82, v82, v5
    v_mul_f32 v83, v83, v5
    v_mul_f32 v84, v84, v5
    v_mul_f32 v85, v85, v5
    v_mul_f32 v86, v86, v5
    v_mul_f32 v87, v87, v5
    v_mul_f32 v88, v88, v5
    v_mul_f32 v89, v89, v5
    v_mul_f32 v90, v90, v5
    v_mul_f32 v91, v91, v5
    v_mul_f32 v92, v92, v5
    v_mul_f32 v93, v93, v5
    v_mul_f32 v94, v94, v5
    v_mul_f32 v95, v95, v5
    v_mul_f32 v96, v96, v5
    v_mul_f32 v97, v97, v5
    v_mul_f32 v98, v98, v5
    v_mul_f32 v99, v99, v5
    v_mul_f32 v100, v100, v5
    v_mul_f32 v101, v101, v5
    v_mul_f32 v102, v102, v5
    v_mul_f32 v103, v103, v5
    v_mul_f32 v104, v104, v5
    v_mul_f32 v105, v105, v5
    v_mul_f32 v106, v106, v5
    v_mul_f32 v107, v107, v5
    v_mul_f32 v108, v108, v5
    v_mul_f32 v109, v109, v5
    v_mul_f32 v110, v110, v5
    v_mul_f32 v111, v111, v5
    v_mul_f32 v112, v112, v5
    v_mul_f32 v113, v113, v5
    v_mul_f32 v114, v114, v5
    v_mul_f32 v115, v115, v5
    v_mul_f32 v116, v116, v5
    v_mul_f32 v117, v117, v5
    v_mul_f32 v118, v118, v5
    v_mul_f32 v119, v119, v5
    v_mul_f32 v120, v120, v5
    v_mul_f32 v121, v121, v5
    v_mul_f32 v122, v122, v5
    v_mul_f32 v123, v123, v5
    v_mul_f32 v124, v124, v5
    v_mul_f32 v125, v125, v5
    v_mul_f32 v126, v126, v5
    v_mul_f32 v127, v127, v5
    s_branch L_back13
L_rare14:
    s_nop 7
    s_nop 7
    v_max_f32 v2, v2, v1
    v_mul_f32 v7, s34, v2
    v_sub_f32 v5, v4, v7
    v_exp_f32 v5, v5
    v_mov_b32 v4, v7
    s_nop 0
    v_mul_f32 v3, v3, v5
    v_mul_f32 v14, v14, v5
    v_mul_f32 v15, v15, v5
    v_sub_f32 v8, 0, v4
    v_sub_f32 v9, 0, v4
    v_mul_f32 v64, v64, v5
    v_mul_f32 v65, v65, v5
    v_mul_f32 v66, v66, v5
    v_mul_f32 v67, v67, v5
    v_mul_f32 v68, v68, v5
    v_mul_f32 v69, v69, v5
    v_mul_f32 v70, v70, v5
    v_mul_f32 v71, v71, v5
    v_mul_f32 v72, v72, v5
    v_mul_f32 v73, v73, v5
    v_mul_f32 v74, v74, v5
    v_mul_f32 v75, v75, v5
    v_mul_f32 v76, v76, v5
    v_mul_f32 v77, v77, v5
    v_mul_f32 v78, v78, v5
    v_mul_f32 v79, v79, v5
    v_mul_f32 v80, v80, v5
    v_mul_f32 v81, v81, v5
    v_mul_f32 v82, v82, v5
    v_mul_f32 v83, v83, v5
    v_mul_f32 v84, v84, v5
    v_mul_f32 v85, v85, v5
    v_mul_f32 v86, v86, v5
    v_mul_f32 v87, v87, v5
    v_mul_f32 v88, v88, v5
    v_mul_f32 v89, v89, v5
    v_mul_f32 v90, v90, v5
    v_mul_f32 v91, v91, v5
    v_mul_f32 v92, v92, v5
    v_mul_f32 v93, v93, v5
    v_mul_f32 v94, v94, v5
    v_mul_f32 v95, v95, v5
    v_mul_f32 v96, v96, v5
    v_mul_f32 v97, v97, v5
    v_mul_f32 v98, v98, v5
    v_mul_f32 v99, v99, v5
    v_mul_f32 v100, v100, v5
    v_mul_f32 v101, v101, v5
    v_mul_f32 v102, v102, v5
    v_mul_f32 v103, v103, v5
    v_mul_f32 v104, v104, v5
    v_mul_f32 v105, v105, v5
    v_mul_f32 v106, v106, v5
    v_mul_f32 v107, v107, v5
    v_mul_f32 v108, v108, v5
    v_mul_f32 v109, v109, v5
    v_mul_f32 v110, v110, v5
    v_mul_f32 v111, v111, v5
    v_mul_f32 v112, v112, v5
    v_mul_f32 v113, v113, v5
    v_mul_f32 v114, v114, v5
    v_mul_f32 v115, v115, v5
    v_mul_f32 v116, v116, v5
    v_mul_f32 v117, v117, v5
    v_mul_f32 v118, v118, v5
    v_mul_f32 v119, v119, v5
    v_mul_f32 v120, v120, v5
    v_mul_f32 v121, v121, v5
    v_mul_f32 v122, v122, v5
    v_mul_f32 v123, v123, v5
    v_mul_f32 v124, v124, v5
    v_mul_f32 v125, v125, v5
    v_mul_f32 v126, v126, v5
    v_mul_f32 v127, v127, v5
    s_branch L_back14
L_rare15:
    s_nop 7
    s_nop 7
    v_max_f32 v2, v2, v1
    v_mul_f32 v7, s34, v2
    v_sub_f32 v5, v4, v7
    v_exp_f32 v5, v5
    v_mov_b32 v4, v7
    s_nop 0
    v_mul_f32 v3, v3, v5
    v_mul_f32 v14, v14, v5
    v_mul_f32 v15, v15, v5
    v_sub_f32 v8, 0, v4
    v_sub_f32 v9, 0, v4
    v_mul_f32 v64, v64, v5
    v_mul_f32 v65, v65, v5
    v_mul_f32 v66, v66, v5
    v_mul_f32 v67, v67, v5
    v_mul_f32 v68, v68, v5
    v_mul_f32 v69, v69, v5
    v_mul_f32 v70, v70, v5
    v_mul_f32 v71, v71, v5
    v_mul_f32 v72, v72, v5
    v_mul_f32 v73, v73, v5
    v_mul_f32 v74, v74, v5
    v_mul_f32 v75, v75, v5
    v_mul_f32 v76, v76, v5
    v_mul_f32 v77, v77, v5
    v_mul_f32 v78, v78, v5
    v_mul_f32 v79, v79, v5
    v_mul_f32 v80, v80, v5
    v_mul_f32 v81, v81, v5
    v_mul_f32 v82, v82, v5
    v_mul_f32 v83, v83, v5
    v_mul_f32 v84, v84, v5
    v_mul_f32 v85, v85, v5
    v_mul_f32 v86, v86, v5
    v_mul_f32 v87, v87, v5
    v_mul_f32 v88, v88, v5
    v_mul_f32 v89, v89, v5
    v_mul_f32 v90, v90, v5
    v_mul_f32 v91, v91, v5
    v_mul_f32 v92, v92, v5
    v_mul_f32 v93, v93, v5
    v_mul_f32 v94, v94, v5
    v_mul_f32 v95, v95, v5
    v_mul_f32 v96, v96, v5
    v_mul_f32 v97, v97, v5
    v_mul_f32 v98, v98, v5
    v_mul_f32 v99, v99, v5
    v_mul_f32 v100, v100, v5
    v_mul_f32 v101, v101, v5
    v_mul_f32 v102, v102, v5
    v_mul_f32 v103, v103, v5
    v_mul_f32 v104, v104, v5
    v_mul_f32 v105, v105, v5
    v_mul_f32 v106, v106, v5
    v_mul_f32 v107, v107, v5
    v_mul_f32 v108, v108, v5
    v_mul_f32 v109, v109, v5
    v_mul_f32 v110, v110, v5
    v_mul_f32 v111, v111, v5
    v_mul_f32 v112, v112, v5
    v_mul_f32 v113, v113, v5
    v_mul_f32 v114, v114, v5
    v_mul_f32 v115, v115, v5
    v_mul_f32 v116, v116, v5
    v_mul_f32 v117, v117, v5
    v_mul_f32 v118, v118, v5
    v_mul_f32 v119, v119, v5
    v_mul_f32 v120, v120, v5
    v_mul_f32 v121, v121, v5
    v_mul_f32 v122, v122, v5
    v_mul_f32 v123, v123, v5
    v_mul_f32 v124, v124, v5
    v_mul_f32 v125, v125, v5
    v_mul_f32 v126, v126, v5
    v_mul_f32 v127, v127, v5
    s_branch L_back15
.section .rodata,"a"
.p2align 6
.amdhsa_kernel standalone__gqa_softmax__near_ridge_kernel
  .amdhsa_next_free_vgpr 256
  .amdhsa_next_free_sgpr 72
  .amdhsa_accum_offset 256
  .amdhsa_group_segment_fixed_size 0
  .amdhsa_kernarg_size 48
  .amdhsa_user_sgpr_count 2
  .amdhsa_user_sgpr_kernarg_segment_ptr 1
  .amdhsa_system_sgpr_workgroup_id_x 1
.end_amdhsa_kernel
```
